```python
import torch

def _softmax(x, axis=-1):
    return torch.softmax(x, dim=axis)
def _gelu(x):
    return torch.nn.functional.gelu(x, approximate="tanh")
def _silu(x):
    return torch.nn.functional.silu(x)
def _sigmoid(x):
    return torch.sigmoid(x)
def _layernorm(x, axis=-1, eps=1e-5):
    m = x.mean(dim=axis, keepdim=True)
    v = x.var(dim=axis, keepdim=True, unbiased=False)
    return (x - m) / torch.sqrt(v + eps)
def _scatter_add(tgt, idx, src, axis=0):
    return tgt.clone().index_add_(axis, idx, src)
def _segment_sum(src, seg, n):
    out = torch.zeros((n,) + src.shape[1:], dtype=src.dtype)
    return out.index_add_(0, seg, src)
def _pad(x, pw):
    flat = tuple(v for pair in reversed(pw) for v in pair)
    return torch.nn.functional.pad(x, flat)

kernel_name = 'parallel_sum__softmax_full_mha__glu_gated_swiglu__prompt'

def setup_inputs():

    _w = (lambda a: (lambda t: t.to(torch.bfloat16) if t.is_floating_point() else t)(torch.as_tensor(a)))
    def _A_setup():
        B, S, D = 1, 2048, 512
        return {
            "x": _w((lambda *s: torch.randn(*s, dtype=torch.bfloat16) * 0.05)(B, S, D)),
            "wqkv": _w((lambda *s: torch.randn(*s, dtype=torch.bfloat16) * 0.05)(D, 3 * D)),
            "wo": _w((lambda *s: torch.randn(*s, dtype=torch.bfloat16) * 0.05)(D, D)),
        }
    _A_in = _A_setup()

    def _B_setup():
        B, S, D, F = 1, 2048, 512, 1792
        return {
            "x": _w((lambda *s: torch.randn(*s, dtype=torch.bfloat16) * 0.05)(B, S, D)),
            "w1": _w((lambda *s: torch.randn(*s, dtype=torch.bfloat16) * 0.4)(D, F) * (2.0 / D) ** 0.5),
            "w3": _w((lambda *s: torch.randn(*s, dtype=torch.bfloat16) * 0.4)(D, F) * (2.0 / D) ** 0.5),
            "w2": _w((lambda *s: torch.randn(*s, dtype=torch.bfloat16) * 0.4)(F, D) * (2.0 / F) ** 0.5),
        }
    _B_in = _B_setup()

    return {
        "A_x": _A_in["x"],
        "A_wqkv": _A_in["wqkv"],
        "A_wo": _A_in["wo"],
        "B_x": _B_in["x"],
        "B_w1": _B_in["w1"],
        "B_w3": _B_in["w3"],
        "B_w2": _B_in["w2"],
    }

def reference(A_x, A_wqkv, A_wo, B_x, B_w1, B_w3, B_w2):
    def _A_ref(x, wqkv, wo):
        B, S, D = x.shape
        H = 32; Dh = D // H
        qkv = (lambda x, *d: x.permute(*d))((x @ wqkv).reshape(B, S, 3, H, Dh), 2, 0, 3, 1, 4)
        q, k, v = qkv[0], qkv[1], qkv[2]
        scale = Dh ** -0.5
        scores = torch.einsum("bhqd,bhkd->bhqk", q, k) * scale
        p = _softmax(scores, axis=-1)
        o = torch.einsum("bhqk,bhkd->bhqd", p, v)
        return (lambda x, *d: x.permute(*d))(o, 0, 2, 1, 3).reshape(B, S, D) @ wo

    def _B_ref(x, w1, w3, w2):
        gate = torch.einsum("bsd,df->bsf", x, w1)
        up = torch.einsum("bsd,df->bsf", x, w3)
        h = _silu(gate) * up
        out = torch.einsum("bsf,fd->bsd", h, w2)
        return out

    x = A_x
    xn = _layernorm(x, axis=-1)
    return x + _A_ref(xn, A_wqkv, A_wo) + _B_ref(xn, B_w1, B_w3, B_w2)
```

```asm
; @launch grid=(256,1,1) block=(768,1,1) lds=162048
.amdgcn_target "amdgcn-amd-amdhsa--gfx950"
.text
.globl parallel_sum__softmax_full_mha__glu_gated_swiglu__prompt_kernel
.p2align 8
.type parallel_sum__softmax_full_mha__glu_gated_swiglu__prompt_kernel,@function
parallel_sum__softmax_full_mha__glu_gated_swiglu__prompt_kernel:
    s_cmp_ge_u32 s2, 256
    s_cbranch_scc1 M_END
    s_load_dwordx2 s[8:9], s[0:1], 72
    s_load_dwordx4 s[4:7], s[0:1], 0
    v_lshrrev_b32 v1, 6, v0
    v_and_b32 v0, 63, v0
    v_readfirstlane_b32 s24, v1
    s_nop 0
    s_cmp_ge_u32 s24, 8
    s_cbranch_scc1 M_GEMM
    s_and_b32 s27, s2, 7
    s_lshr_b32 s28, s2, 3
    s_lshr_b32 s25, s27, 1
    s_lshl_b32 s25, s25, 3
    s_lshr_b32 s29, s28, 2
    s_add_u32 s25, s25, s29
    s_and_b32 s26, s27, 1
    s_lshl_b32 s26, s26, 2
    s_and_b32 s29, s28, 3
    s_add_u32 s26, s26, s29
    s_add_u32 s40, s25, s26
    s_and_b32 s40, s40, 7
    s_lshr_b32 s40, s27, 0
    s_bfe_u32 s56, s24, 0x10001
    s_and_b32 s59, s24, 1
    s_cmp_ge_u32 s24, 4
    s_cbranch_scc1 K1_COMP
    s_and_b32 s57, s24, 3
    v_lshrrev_b32 v40, 3, v0
    v_lshlrev_b32 v44, 10, v40
    v_lshrrev_b32 v41, 4, v0
    v_and_b32 v42, 7, v0
    v_xor_b32 v43, v41, v42
    v_lshl_add_u32 v1, v43, 4, v44
    v_xor_b32 v43, 4, v43
    v_lshl_add_u32 v2, v43, 4, v44
    v_add_u32 v2, 7168, v2
    v_mul_u32_u24 v40, 3072, v40
    v_and_b32 v41, 1, v41
    v_lshlrev_b32 v41, 2, v41
    v_xor_b32 v41, v41, v42
    v_lshl_add_u32 v3, v41, 4, v40
    s_lshl_b32 s31, s25, 16
    s_lshl_b32 s33, s57, 14
    s_add_u32 s31, s31, s33
    s_lshl_b32 s32, s57, 11
    s_mul_i32 s35, s57, 49152
    s_lshl_b32 s33, s26, 7
    s_add_u32 s35, s35, s33
    s_mul_i32 s36, s57, 6144
    s_add_u32 s36, s36, 8192
    s_mov_b32 s42, 0
    s_mov_b32 s43, 0x10000
    s_mov_b32 s41, s40
    s_waitcnt lgkmcnt(0)
    s_mov_b32 s12, s4
    s_and_b32 s13, s5, 0xffff
    s_mov_b32 s14, 2097152
    s_mov_b32 s15, 0x20000
    s_mov_b32 s16, s6
    s_and_b32 s17, s7, 0xffff
    s_mov_b32 s18, 1572864
    s_mov_b32 s19, 0x20000
K1_LP:
    s_lshl_b32 s33, s41, 7
    s_add_u32 m0, s43, s32
    s_add_u32 s33, s33, s31
    buffer_load_dwordx4 v1, s[12:15], s33 offen lds
    buffer_load_dwordx4 v2, s[12:15], s33 offen offset:1024 lds
    s_mul_i32 s33, s41, 196608
    s_add_u32 m0, s43, s36
    s_add_u32 s33, s33, s35
    buffer_load_dwordx4 v3, s[16:19], s33 offen offset:0 lds
    buffer_load_dwordx4 v3, s[16:19], s33 offen offset:1024 lds
    buffer_load_dwordx4 v3, s[16:19], s33 offen offset:2048 lds
    s_add_u32 m0, m0, 3072
    s_add_u32 s33, s33, 24576
    buffer_load_dwordx4 v3, s[16:19], s33 offen offset:0 lds
    buffer_load_dwordx4 v3, s[16:19], s33 offen offset:1024 lds
    buffer_load_dwordx4 v3, s[16:19], s33 offen offset:2048 lds
    s_add_u32 s41, s41, 1
    s_and_b32 s41, s41, 7
    s_add_u32 s43, s43, 32768
    s_and_b32 s43, s43, 0x1ffff
    s_add_u32 s42, s42, 1
    s_cmp_lt_u32 s42, 3
    s_cbranch_scc1 K1_LP
    v_and_b32 v48, 31, v0
    v_lshrrev_b32 v49, 5, v0
    v_bfe_u32 v50, v0, 1, 3
    s_lshl_b32 s33, s56, 12
    v_lshl_add_u32 v51, v48, 7, s33
    s_lshl_b32 s33, s59, 2
    v_or_b32 v52, s33, v49
    v_xor_b32 v52, v52, v50
    v_lshl_add_u32 v4, v52, 4, v51
    v_xor_b32 v5, 32, v4
    v_add_u32 v8, 0x10000, v4
    v_add_u32 v9, 0x10000, v5
    v_mov_b32 v13, 0xffff0000
    v_mov_b32 v54, 0
    v_mov_b32 v55, 0
    v_mov_b32 v56, 0
    v_mov_b32 v57, 0
    v_mov_b32 v58, 0
    v_mov_b32 v59, 0
    v_mov_b32 v60, 0
    v_mov_b32 v61, 0
    s_mov_b32 s20, s8
    s_and_b32 s21, s9, 0xffff
    s_mov_b32 s22, 33554432
    s_mov_b32 s23, 0x20000
    s_mov_b32 s42, 0
    s_mov_b32 s44, 0x10000
K1_LA:
    s_waitcnt vmcnt(16)
    s_barrier
    ds_read_b128 v[16:19], v8
    ds_read_b128 v[20:23], v9
    s_add_u32 s44, s44, 32768
    s_and_b32 s44, s44, 0x1ffff
    v_add_u32 v8, s44, v4
    v_add_u32 v9, s44, v5
    s_lshl_b32 s33, s41, 7
    s_add_u32 m0, s43, s32
    s_add_u32 s33, s33, s31
    buffer_load_dwordx4 v1, s[12:15], s33 offen lds
    buffer_load_dwordx4 v2, s[12:15], s33 offen offset:1024 lds
    s_waitcnt lgkmcnt(0)
    s_mul_i32 s33, s41, 196608
    v_lshlrev_b32 v24, 16, v16
    v_and_b32 v25, v13, v16
    v_lshlrev_b32 v26, 16, v17
    s_add_u32 m0, s43, s36
    v_and_b32 v27, v13, v17
    v_lshlrev_b32 v28, 16, v18
    v_and_b32 v29, v13, v18
    s_add_u32 s33, s33, s35
    v_lshlrev_b32 v30, 16, v19
    v_and_b32 v31, v13, v19
    v_lshlrev_b32 v32, 16, v20
    buffer_load_dwordx4 v3, s[16:19], s33 offen offset:0 lds
    v_and_b32 v33, v13, v20
    v_lshlrev_b32 v34, 16, v21
    v_and_b32 v35, v13, v21
    buffer_load_dwordx4 v3, s[16:19], s33 offen offset:1024 lds
    v_lshlrev_b32 v36, 16, v22
    v_and_b32 v37, v13, v22
    v_lshlrev_b32 v38, 16, v23
    v_and_b32 v39, v13, v23
    buffer_load_dwordx4 v3, s[16:19], s33 offen offset:2048 lds
    v_add_f32 v54, v54, v24
    v_fmac_f32 v58, v24, v24
    v_add_f32 v55, v55, v25
    s_add_u32 m0, m0, 3072
    v_fmac_f32 v59, v25, v25
    v_add_f32 v56, v56, v26
    v_fmac_f32 v60, v26, v26
    s_add_u32 s33, s33, 24576
    v_add_f32 v57, v57, v27
    v_fmac_f32 v61, v27, v27
    v_add_f32 v54, v54, v28
    buffer_load_dwordx4 v3, s[16:19], s33 offen offset:0 lds
    v_fmac_f32 v58, v28, v28
    v_add_f32 v55, v55, v29
    v_fmac_f32 v59, v29, v29
    buffer_load_dwordx4 v3, s[16:19], s33 offen offset:1024 lds
    v_add_f32 v56, v56, v30
    v_fmac_f32 v60, v30, v30
    v_add_f32 v57, v57, v31
    v_fmac_f32 v61, v31, v31
    buffer_load_dwordx4 v3, s[16:19], s33 offen offset:2048 lds
    v_add_f32 v54, v54, v32
    v_fmac_f32 v58, v32, v32
    v_add_f32 v55, v55, v33
    s_add_u32 s41, s41, 1
    v_fmac_f32 v59, v33, v33
    v_add_f32 v56, v56, v34
    v_fmac_f32 v60, v34, v34
    s_and_b32 s41, s41, 7
    v_add_f32 v57, v57, v35
    v_fmac_f32 v61, v35, v35
    v_add_f32 v54, v54, v36
    s_add_u32 s43, s43, 32768
    v_fmac_f32 v58, v36, v36
    v_add_f32 v55, v55, v37
    v_fmac_f32 v59, v37, v37
    s_and_b32 s43, s43, 0x1ffff
    v_add_f32 v56, v56, v38
    v_fmac_f32 v60, v38, v38
    v_add_f32 v57, v57, v39
    v_fmac_f32 v61, v39, v39
    s_add_u32 s42, s42, 1
    s_cmp_lt_u32 s42, 5
    s_cbranch_scc1 K1_LA
    s_waitcnt vmcnt(16)
K1_LB:
    s_barrier
    ds_read_b128 v[16:19], v8
    ds_read_b128 v[20:23], v9
    s_add_u32 s44, s44, 32768
    s_and_b32 s44, s44, 0x1ffff
    v_add_u32 v8, s44, v4
    v_add_u32 v9, s44, v5
    s_waitcnt lgkmcnt(0)
    v_lshlrev_b32 v24, 16, v16
    v_and_b32 v25, v13, v16
    v_lshlrev_b32 v26, 16, v17
    v_and_b32 v27, v13, v17
    v_lshlrev_b32 v28, 16, v18
    v_and_b32 v29, v13, v18
    v_lshlrev_b32 v30, 16, v19
    v_and_b32 v31, v13, v19
    v_lshlrev_b32 v32, 16, v20
    v_and_b32 v33, v13, v20
    v_lshlrev_b32 v34, 16, v21
    v_and_b32 v35, v13, v21
    v_lshlrev_b32 v36, 16, v22
    v_and_b32 v37, v13, v22
    v_lshlrev_b32 v38, 16, v23
    v_and_b32 v39, v13, v23
    v_add_f32 v54, v54, v24
    v_fmac_f32 v58, v24, v24
    v_add_f32 v55, v55, v25
    v_fmac_f32 v59, v25, v25
    v_add_f32 v56, v56, v26
    v_fmac_f32 v60, v26, v26
    v_add_f32 v57, v57, v27
    v_fmac_f32 v61, v27, v27
    v_add_f32 v54, v54, v28
    v_fmac_f32 v58, v28, v28
    v_add_f32 v55, v55, v29
    v_fmac_f32 v59, v29, v29
    v_add_f32 v56, v56, v30
    v_fmac_f32 v60, v30, v30
    v_add_f32 v57, v57, v31
    v_fmac_f32 v61, v31, v31
    v_add_f32 v54, v54, v32
    v_fmac_f32 v58, v32, v32
    v_add_f32 v55, v55, v33
    v_fmac_f32 v59, v33, v33
    v_add_f32 v56, v56, v34
    v_fmac_f32 v60, v34, v34
    v_add_f32 v57, v57, v35
    v_fmac_f32 v61, v35, v35
    v_add_f32 v54, v54, v36
    v_fmac_f32 v58, v36, v36
    v_add_f32 v55, v55, v37
    v_fmac_f32 v59, v37, v37
    v_add_f32 v56, v56, v38
    v_fmac_f32 v60, v38, v38
    v_add_f32 v57, v57, v39
    v_fmac_f32 v61, v39, v39
    s_add_u32 s42, s42, 1
    s_waitcnt vmcnt(8)
    s_cmp_lt_u32 s42, 7
    s_cbranch_scc1 K1_LB
    s_waitcnt vmcnt(0)
    s_cmp_lt_u32 s42, 8
    s_cbranch_scc1 K1_LB
    v_add_f32 v54, v54, v55
    v_add_f32 v56, v56, v57
    v_add_f32 v58, v58, v59
    v_add_f32 v60, v60, v61
    v_add_f32 v54, v54, v56
    v_add_f32 v58, v58, v60
    v_mov_b32 v55, v54
    v_mov_b32 v59, v58
    s_lshl_b32 s33, s56, 9
    s_add_u32 s33, s33, 159744
    v_lshl_add_u32 v6, v48, 4, s33
    v_permlane32_swap_b32 v54, v55
    v_permlane32_swap_b32 v58, v59
    s_lshl_b32 s33, s59, 3
    v_add_u32 v7, s33, v6
    v_add_f32 v54, v54, v55
    v_add_f32 v55, v58, v59
    ds_write_b64 v7, v[54:55]
    s_waitcnt lgkmcnt(0)
    s_barrier
    s_mov_b32 s44, 0x7fffffff
    s_branch AT_ENTRY
K1_COMP:
    v_and_b32 v144, 31, v0
    v_lshrrev_b32 v145, 5, v0
    v_bfe_u32 v146, v0, 1, 3
    s_lshl_b32 s33, s56, 12
    v_lshl_add_u32 v147, v144, 7, s33
    s_lshl_b32 s33, s56, 2
    v_or_b32 v148, s33, v145
    v_xor_b32 v148, v148, v146
    v_lshl_add_u32 v4, v148, 4, v147
    v_xor_b32 v5, 32, v4
    v_xor_b32 v6, 64, v4
    v_xor_b32 v7, 96, v4
    v_mul_u32_u24 v147, 3072, v145
    v_bfe_u32 v148, v0, 2, 2
    v_lshl_add_u32 v147, v148, 7, v147
    v_bfe_u32 v148, v0, 3, 1
    v_xor_b32 v148, s59, v148
    v_lshl_add_u32 v147, v148, 6, v147
    v_bfe_u32 v149, v0, 4, 1
    v_lshl_add_u32 v147, v149, 5, v147
    v_and_b32 v148, 3, v0
    v_lshl_add_u32 v147, v148, 3, v147
    s_mul_i32 s33, s56, 12288
    s_add_u32 s34, s33, 8192
    v_add_u32 v8, s34, v147
    s_sub_u32 s34, 20480, s33
    v_add_u32 v9, s34, v147
    v_bfe_u32 v147, v0, 2, 1
    v_xor_b32 v147, v147, v149
    v_or_b32 v147, v147, v148
    v_cmp_eq_u32 vcc, 0, v147
    v_mov_b32 v147, 0x3f803f80
    s_nop 0
    v_cndmask_b32 v140, 0, v147, vcc
    v_mov_b32 v141, v140
    v_mov_b32 v142, v140
    v_mov_b32 v143, v140
    v_mov_b32 v48, 0
    v_mov_b32 v49, 0
    v_mov_b32 v50, 0
    v_mov_b32 v51, 0
    v_mov_b32 v52, 0
    v_mov_b32 v53, 0
    v_mov_b32 v54, 0
    v_mov_b32 v55, 0
    v_mov_b32 v56, 0
    v_mov_b32 v57, 0
    v_mov_b32 v58, 0
    v_mov_b32 v59, 0
    v_mov_b32 v60, 0
    v_mov_b32 v61, 0
    v_mov_b32 v62, 0
    v_mov_b32 v63, 0
    v_mov_b32 v64, 0
    v_mov_b32 v65, 0
    v_mov_b32 v66, 0
    v_mov_b32 v67, 0
    v_mov_b32 v68, 0
    v_mov_b32 v69, 0
    v_mov_b32 v70, 0
    v_mov_b32 v71, 0
    v_mov_b32 v72, 0
    v_mov_b32 v73, 0
    v_mov_b32 v74, 0
    v_mov_b32 v75, 0
    v_mov_b32 v76, 0
    v_mov_b32 v77, 0
    v_mov_b32 v78, 0
    v_mov_b32 v79, 0
    v_mov_b32 v80, 0
    v_mov_b32 v81, 0
    v_mov_b32 v82, 0
    v_mov_b32 v83, 0
    v_mov_b32 v84, 0
    v_mov_b32 v85, 0
    v_mov_b32 v86, 0
    v_mov_b32 v87, 0
    v_mov_b32 v88, 0
    v_mov_b32 v89, 0
    v_mov_b32 v90, 0
    v_mov_b32 v91, 0
    v_mov_b32 v92, 0
    v_mov_b32 v93, 0
    v_mov_b32 v94, 0
    v_mov_b32 v95, 0
    v_mov_b32 v96, 0
    v_mov_b32 v97, 0
    v_mov_b32 v98, 0
    v_mov_b32 v99, 0
    v_mov_b32 v100, 0
    v_mov_b32 v101, 0
    v_mov_b32 v102, 0
    v_mov_b32 v103, 0
    v_mov_b32 v104, 0
    v_mov_b32 v105, 0
    v_mov_b32 v106, 0
    v_mov_b32 v107, 0
    v_mov_b32 v108, 0
    v_mov_b32 v109, 0
    v_mov_b32 v110, 0
    v_mov_b32 v111, 0
    v_mov_b32 v112, 0
    v_mov_b32 v113, 0
    v_mov_b32 v114, 0
    v_mov_b32 v115, 0
    v_mov_b32 v116, 0
    v_mov_b32 v117, 0
    v_mov_b32 v118, 0
    v_mov_b32 v119, 0
    v_mov_b32 v120, 0
    v_mov_b32 v121, 0
    v_mov_b32 v122, 0
    v_mov_b32 v123, 0
    v_mov_b32 v124, 0
    v_mov_b32 v125, 0
    v_mov_b32 v126, 0
    v_mov_b32 v127, 0
    v_mov_b32 v128, 0
    v_mov_b32 v129, 0
    v_mov_b32 v130, 0
    v_mov_b32 v131, 0
    v_mov_b32 v132, 0
    v_mov_b32 v133, 0
    v_mov_b32 v134, 0
    v_mov_b32 v135, 0
    v_mov_b32 v136, 0
    v_mov_b32 v137, 0
    v_mov_b32 v138, 0
    v_mov_b32 v139, 0
    s_lshl_b32 s30, s25, 1
    s_add_u32 s30, s30, s56
    s_lshl_b32 s33, s26, 1
    s_add_u32 s33, s33, s59
    s_mul_i32 s33, s33, 131072
    s_lshl_b32 s34, s30, 10
    s_add_u32 s33, s33, s34
    s_add_u32 s34, s33, 2097152
    s_add_u32 s35, s33, 4194304
    s_add_u32 s33, s33, 0
    s_add_u32 s36, s33, 65536
    s_add_u32 s37, s34, 65536
    v_lshlrev_b32 v15, 4, v0
    v_bfe_u32 v150, v0, 2, 1
    v_bfe_u32 v151, v0, 3, 1
    v_xor_b32 v150, v150, v151
    v_mul_u32_u24 v150, 192, v150
    v_xor_b32 v150, v150, v15
    s_lshl_b32 s38, s56, 9
    s_add_u32 s38, s38, 159744
    v_lshl_add_u32 v1, v144, 4, s38
    s_lshl_b32 s38, s59, 10
    s_add_u32 s38, s38, 157696
    v_lshl_add_u32 v2, v144, 5, s38
    s_lshl_b32 s38, s56, 4
    v_add_u32 v10, s38, v2
    v_xor_b32 v2, 16, v10
    s_and_b32 s38, s24, 3
    s_lshl_b32 s38, s38, 7
    s_add_u32 s38, s38, 160768
    v_lshl_add_u32 v11, v144, 2, s38
    v_lshl_add_u32 v14, v145, 4, s38
    v_mul_u32_u24 v3, 65536, v149
    v_lshl_add_u32 v3, v145, 8, v3
    v_and_b32 v148, 15, v0
    v_lshl_add_u32 v3, v148, 4, v3
    v_mov_b32 v13, 0xffff0000
    s_mov_b32 s42, 0
    s_waitcnt lgkmcnt(0)
    s_mov_b32 s20, s8
    s_and_b32 s21, s9, 0xffff
    s_mov_b32 s22, 33554432
    s_mov_b32 s23, 0x20000
    v_xor_b32 v4, 0x10000, v4
    v_xor_b32 v5, 0x10000, v5
    v_xor_b32 v6, 0x10000, v6
    v_xor_b32 v7, 0x10000, v7
    v_xor_b32 v8, 0x10000, v8
    v_xor_b32 v9, 0x10000, v9
K1_CL:
    s_barrier
    v_mfma_f32_32x32x16_bf16 v[80:95], v[52:55], v[48:51], v[80:95]
    ds_read_b128 v[16:19], v4 offset:0
    ds_read_b64_tr_b16 v[20:21], v8 offset:0
    v_mfma_f32_32x32x16_bf16 v[96:111], v[56:59], v[48:51], v[96:111]
    ds_read_b64_tr_b16 v[22:23], v8 offset:512
    ds_read_b64_tr_b16 v[24:25], v8 offset:1024
    v_mfma_f32_32x32x16_bf16 v[112:127], v[48:51], v[60:63], v[112:127]
    ds_read_b64_tr_b16 v[26:27], v8 offset:1536
    ds_read_b64_tr_b16 v[28:29], v8 offset:2048
    ds_read_b64_tr_b16 v[30:31], v8 offset:2560
    v_mfma_f32_32x32x16_bf16 v[80:95], v[68:71], v[64:67], v[80:95]
    ds_read_b128 v[32:35], v5 offset:0
    ds_read_b64_tr_b16 v[36:37], v8 offset:6144
    v_mfma_f32_32x32x16_bf16 v[96:111], v[72:75], v[64:67], v[96:111]
    ds_read_b64_tr_b16 v[38:39], v8 offset:6656
    ds_read_b64_tr_b16 v[40:41], v8 offset:7168
    v_mfma_f32_32x32x16_bf16 v[112:127], v[64:67], v[76:79], v[112:127]
    ds_read_b64_tr_b16 v[42:43], v8 offset:7680
    ds_read_b64_tr_b16 v[44:45], v8 offset:8192
    ds_read_b64_tr_b16 v[46:47], v8 offset:8704
    s_waitcnt lgkmcnt(7)
    v_mfma_f32_32x32x16_bf16 v[80:95], v[20:23], v[16:19], v[80:95]
    ds_read_b128 v[48:51], v6 offset:0
    v_mfma_f32_16x16x32_bf16 v[128:131], v[140:143], v[20:23], v[128:131]
    ds_read_b64_tr_b16 v[52:53], v9 offset:0
    v_mfma_f32_32x32x16_bf16 v[96:111], v[24:27], v[16:19], v[96:111]
    ds_read_b64_tr_b16 v[54:55], v9 offset:512
    v_mfma_f32_16x16x32_bf16 v[132:135], v[140:143], v[24:27], v[132:135]
    ds_read_b64_tr_b16 v[56:57], v9 offset:1024
    v_mfma_f32_32x32x16_bf16 v[112:127], v[16:19], v[28:31], v[112:127]
    ds_read_b64_tr_b16 v[58:59], v9 offset:1536
    v_mfma_f32_16x16x32_bf16 v[136:139], v[140:143], v[28:31], v[136:139]
    ds_read_b64_tr_b16 v[60:61], v9 offset:2048
    ds_read_b64_tr_b16 v[62:63], v9 offset:2560
    s_waitcnt lgkmcnt(7)
    v_mfma_f32_32x32x16_bf16 v[80:95], v[36:39], v[32:35], v[80:95]
    ds_read_b128 v[64:67], v7 offset:0
    v_mfma_f32_16x16x32_bf16 v[128:131], v[140:143], v[36:39], v[128:131]
    ds_read_b64_tr_b16 v[68:69], v9 offset:6144
    v_mfma_f32_32x32x16_bf16 v[96:111], v[40:43], v[32:35], v[96:111]
    ds_read_b64_tr_b16 v[70:71], v9 offset:6656
    v_mfma_f32_16x16x32_bf16 v[132:135], v[140:143], v[40:43], v[132:135]
    ds_read_b64_tr_b16 v[72:73], v9 offset:7168
    v_mfma_f32_32x32x16_bf16 v[112:127], v[32:35], v[44:47], v[112:127]
    ds_read_b64_tr_b16 v[74:75], v9 offset:7680
    v_mfma_f32_16x16x32_bf16 v[136:139], v[140:143], v[44:47], v[136:139]
    ds_read_b64_tr_b16 v[76:77], v9 offset:8192
    ds_read_b64_tr_b16 v[78:79], v9 offset:8704
    s_waitcnt lgkmcnt(0)
    s_barrier
    v_mfma_f32_32x32x16_bf16 v[80:95], v[52:55], v[48:51], v[80:95]
    ds_read_b128 v[16:19], v4 offset:32768
    ds_read_b64_tr_b16 v[20:21], v8 offset:32768
    v_mfma_f32_32x32x16_bf16 v[96:111], v[56:59], v[48:51], v[96:111]
    ds_read_b64_tr_b16 v[22:23], v8 offset:33280
    ds_read_b64_tr_b16 v[24:25], v8 offset:33792
    v_mfma_f32_32x32x16_bf16 v[112:127], v[48:51], v[60:63], v[112:127]
    ds_read_b64_tr_b16 v[26:27], v8 offset:34304
    ds_read_b64_tr_b16 v[28:29], v8 offset:34816
    ds_read_b64_tr_b16 v[30:31], v8 offset:35328
    v_mfma_f32_32x32x16_bf16 v[80:95], v[68:71], v[64:67], v[80:95]
    ds_read_b128 v[32:35], v5 offset:32768
    ds_read_b64_tr_b16 v[36:37], v8 offset:38912
    v_mfma_f32_32x32x16_bf16 v[96:111], v[72:75], v[64:67], v[96:111]
    ds_read_b64_tr_b16 v[38:39], v8 offset:39424
    ds_read_b64_tr_b16 v[40:41], v8 offset:39936
    v_mfma_f32_32x32x16_bf16 v[112:127], v[64:67], v[76:79], v[112:127]
    ds_read_b64_tr_b16 v[42:43], v8 offset:40448
    ds_read_b64_tr_b16 v[44:45], v8 offset:40960
    ds_read_b64_tr_b16 v[46:47], v8 offset:41472
    s_waitcnt lgkmcnt(7)
    v_mfma_f32_32x32x16_bf16 v[80:95], v[20:23], v[16:19], v[80:95]
    ds_read_b128 v[48:51], v6 offset:32768
    v_mfma_f32_16x16x32_bf16 v[128:131], v[140:143], v[20:23], v[128:131]
    ds_read_b64_tr_b16 v[52:53], v9 offset:32768
    v_mfma_f32_32x32x16_bf16 v[96:111], v[24:27], v[16:19], v[96:111]
    ds_read_b64_tr_b16 v[54:55], v9 offset:33280
    v_mfma_f32_16x16x32_bf16 v[132:135], v[140:143], v[24:27], v[132:135]
    ds_read_b64_tr_b16 v[56:57], v9 offset:33792
    v_mfma_f32_32x32x16_bf16 v[112:127], v[16:19], v[28:31], v[112:127]
    ds_read_b64_tr_b16 v[58:59], v9 offset:34304
    v_mfma_f32_16x16x32_bf16 v[136:139], v[140:143], v[28:31], v[136:139]
    ds_read_b64_tr_b16 v[60:61], v9 offset:34816
    ds_read_b64_tr_b16 v[62:63], v9 offset:35328
    s_waitcnt lgkmcnt(7)
    v_mfma_f32_32x32x16_bf16 v[80:95], v[36:39], v[32:35], v[80:95]
    ds_read_b128 v[64:67], v7 offset:32768
    v_mfma_f32_16x16x32_bf16 v[128:131], v[140:143], v[36:39], v[128:131]
    ds_read_b64_tr_b16 v[68:69], v9 offset:38912
    v_mfma_f32_32x32x16_bf16 v[96:111], v[40:43], v[32:35], v[96:111]
    ds_read_b64_tr_b16 v[70:71], v9 offset:39424
    v_mfma_f32_16x16x32_bf16 v[132:135], v[140:143], v[40:43], v[132:135]
    ds_read_b64_tr_b16 v[72:73], v9 offset:39936
    v_mfma_f32_32x32x16_bf16 v[112:127], v[32:35], v[44:47], v[112:127]
    ds_read_b64_tr_b16 v[74:75], v9 offset:40448
    v_mfma_f32_16x16x32_bf16 v[136:139], v[140:143], v[44:47], v[136:139]
    ds_read_b64_tr_b16 v[76:77], v9 offset:40960
    ds_read_b64_tr_b16 v[78:79], v9 offset:41472
    v_xor_b32 v4, 0x10000, v4
    v_xor_b32 v5, 0x10000, v5
    v_xor_b32 v6, 0x10000, v6
    v_xor_b32 v7, 0x10000, v7
    v_xor_b32 v8, 0x10000, v8
    v_xor_b32 v9, 0x10000, v9
    s_add_u32 s42, s42, 1
    s_cmp_lt_u32 s42, 4
    s_waitcnt lgkmcnt(0)
    s_cbranch_scc1 K1_CL
    v_mfma_f32_32x32x16_bf16 v[80:95], v[52:55], v[48:51], v[80:95]
    v_mfma_f32_32x32x16_bf16 v[96:111], v[56:59], v[48:51], v[96:111]
    v_mfma_f32_32x32x16_bf16 v[112:127], v[48:51], v[60:63], v[112:127]
    v_mov_b32 v129, v132
    v_mov_b32 v130, v136
    ds_write_b128 v10, v[128:131]
    v_mfma_f32_32x32x16_bf16 v[80:95], v[68:71], v[64:67], v[80:95]
    v_mfma_f32_32x32x16_bf16 v[96:111], v[72:75], v[64:67], v[96:111]
    v_mfma_f32_32x32x16_bf16 v[112:127], v[64:67], v[76:79], v[112:127]
    s_waitcnt lgkmcnt(0)
    s_barrier
    ds_read_b128 v[16:19], v1
    ds_read_b128 v[20:23], v2
    s_waitcnt lgkmcnt(1)
    v_add_f32 v16, v16, v18
    v_add_f32 v17, v17, v19
    v_mul_f32 v16, 0x3b000000, v16
    v_mul_f32 v17, 0x3b000000, v17
    v_fma_f32 v17, -v16, v16, v17
    v_max_f32 v17, 0, v17
    v_cvt_pk_bf16_f32 v16, v16, v17
    v_and_b32 v17, v13, v16
    v_lshlrev_b32 v18, 16, v16
    v_add_f32 v17, 0x3727c5ac, v17
    v_cvt_pk_bf16_f32 v17, v17, v17
    v_lshlrev_b32 v17, 16, v17
    v_sqrt_f32 v17, v17
    s_nop 0
    v_cvt_pk_bf16_f32 v17, v17, v17
    v_lshlrev_b32 v17, 16, v17
    v_rcp_f32 v12, v17
    s_nop 0
    ds_write_b32 v11, v12
    ds_read_b128 v[48:51], v14 offset:0
    ds_read_b128 v[52:55], v14 offset:32
    ds_read_b128 v[56:59], v14 offset:64
    ds_read_b128 v[60:63], v14 offset:96
    v_cvt_pk_bf16_f32 v24, -v18, -v18
    v_lshrrev_b32 v25, 16, v24
    v_mov_b32 v26, 0
    v_mov_b32 v27, 0
    s_mov_b32 exec_lo, 0
    v_mov_b32 v24, 0
    v_mov_b32 v25, 0
    s_mov_b32 exec_lo, -1
    v_add_f32 v30, v128, v20
    v_and_b32 v31, v13, v30
    v_sub_f32 v30, v30, v31
    v_and_b32 v29, v13, v30
    v_sub_f32 v30, v30, v29
    v_lshrrev_b32 v31, 16, v31
    v_or_b32 v28, v31, v29
    v_lshrrev_b32 v29, 16, v30
    v_mov_b32 v30, 0
    v_mov_b32 v31, 0
    v_add_f32 v34, v129, v21
    v_and_b32 v35, v13, v34
    v_sub_f32 v34, v34, v35
    v_and_b32 v33, v13, v34
    v_sub_f32 v34, v34, v33
    v_lshrrev_b32 v35, 16, v35
    v_or_b32 v32, v35, v33
    v_lshrrev_b32 v33, 16, v34
    v_mov_b32 v34, 0
    v_mov_b32 v35, 0
    v_add_f32 v38, v130, v22
    v_and_b32 v39, v13, v38
    v_sub_f32 v38, v38, v39
    v_and_b32 v37, v13, v38
    v_sub_f32 v38, v38, v37
    v_lshrrev_b32 v39, 16, v39
    v_or_b32 v36, v39, v37
    v_lshrrev_b32 v37, 16, v38
    v_mov_b32 v38, 0
    v_mov_b32 v39, 0
    v_mfma_f32_32x32x16_bf16 v[96:111], v[32:35], v[24:27], v[96:111]
    s_nop 0
    v_mfma_f32_32x32x16_bf16 v[112:127], v[24:27], v[36:39], v[112:127]
    v_mfma_f32_32x32x16_bf16 v[80:95], v[28:31], v[24:27], v[80:95]
    v_mul_f32 v10, 0x3eb8aa3b, v12
    s_waitcnt lgkmcnt(0)
    s_nop 6
    v_mul_f32 v96, v12, v96
    v_mul_f32 v97, v12, v97
    v_mul_f32 v98, v12, v98
    v_mul_f32 v99, v12, v99
    v_mul_f32 v100, v12, v100
    v_mul_f32 v101, v12, v101
    v_mul_f32 v102, v12, v102
    v_mul_f32 v103, v12, v103
    v_cvt_pk_bf16_f32 v40, v96, v97
    v_cvt_pk_bf16_f32 v41, v98, v99
    v_cvt_pk_bf16_f32 v42, v100, v101
    v_cvt_pk_bf16_f32 v43, v102, v103
    buffer_store_dwordx4 v[40:43], v150, s[20:23], s34 offen sc1
    v_mul_f32 v104, v12, v104
    v_mul_f32 v105, v12, v105
    v_mul_f32 v106, v12, v106
    v_mul_f32 v107, v12, v107
    v_mul_f32 v108, v12, v108
    v_mul_f32 v109, v12, v109
    v_mul_f32 v110, v12, v110
    v_mul_f32 v111, v12, v111
    v_cvt_pk_bf16_f32 v44, v104, v105
    v_cvt_pk_bf16_f32 v45, v106, v107
    v_cvt_pk_bf16_f32 v46, v108, v109
    v_cvt_pk_bf16_f32 v47, v110, v111
    buffer_store_dwordx4 v[44:47], v150, s[20:23], s37 offen sc1
    v_mul_f32 v112, v48, v112
    v_mul_f32 v113, v49, v113
    v_mul_f32 v114, v50, v114
    v_mul_f32 v115, v51, v115
    v_mul_f32 v116, v52, v116
    v_mul_f32 v117, v53, v117
    v_mul_f32 v118, v54, v118
    v_mul_f32 v119, v55, v119
    v_cvt_pk_bf16_f32 v64, v112, v113
    v_cvt_pk_bf16_f32 v65, v114, v115
    v_cvt_pk_bf16_f32 v66, v116, v117
    v_cvt_pk_bf16_f32 v67, v118, v119
    buffer_store_dwordx4 v[64:67], v3, s[20:23], s35 offen offset:0 sc1
    v_mul_f32 v120, v56, v120
    v_mul_f32 v121, v57, v121
    v_mul_f32 v122, v58, v122
    v_mul_f32 v123, v59, v123
    v_mul_f32 v124, v60, v124
    v_mul_f32 v125, v61, v125
    v_mul_f32 v126, v62, v126
    v_mul_f32 v127, v63, v127
    v_cvt_pk_bf16_f32 v68, v120, v121
    v_cvt_pk_bf16_f32 v69, v122, v123
    v_cvt_pk_bf16_f32 v70, v124, v125
    v_cvt_pk_bf16_f32 v71, v126, v127
    buffer_store_dwordx4 v[68:71], v3, s[20:23], s35 offen offset:512 sc1
    v_mul_f32 v80, v10, v80
    v_mul_f32 v81, v10, v81
    v_mul_f32 v82, v10, v82
    v_mul_f32 v83, v10, v83
    v_mul_f32 v84, v10, v84
    v_mul_f32 v85, v10, v85
    v_mul_f32 v86, v10, v86
    v_mul_f32 v87, v10, v87
    v_cvt_pk_bf16_f32 v72, v80, v81
    v_cvt_pk_bf16_f32 v73, v82, v83
    v_cvt_pk_bf16_f32 v74, v84, v85
    v_cvt_pk_bf16_f32 v75, v86, v87
    buffer_store_dwordx4 v[72:75], v15, s[20:23], s33 offen sc1
    v_mul_f32 v88, v10, v88
    v_mul_f32 v89, v10, v89
    v_mul_f32 v90, v10, v90
    v_mul_f32 v91, v10, v91
    v_mul_f32 v92, v10, v92
    v_mul_f32 v93, v10, v93
    v_mul_f32 v94, v10, v94
    v_mul_f32 v95, v10, v95
    v_cvt_pk_bf16_f32 v76, v88, v89
    v_cvt_pk_bf16_f32 v77, v90, v91
    v_cvt_pk_bf16_f32 v78, v92, v93
    v_cvt_pk_bf16_f32 v79, v94, v95
    buffer_store_dwordx4 v[76:79], v15, s[20:23], s36 offen sc1
    s_lshl_b32 s44, s26, 1
    s_add_u32 s44, s44, s59
    s_mul_i32 s44, s44, 8448
    s_lshl_b32 s39, s30, 7
    s_add_u32 s44, s44, s39
    s_add_u32 s44, s44, 23199744
AT_ENTRY:
    v_mov_b32 v150, 157516
    ds_read_b32 v143, v150
    s_nop 1
    v_lshlrev_b32 v1, 4, v0
    s_lshl_b32 s28, s24, 8
    s_add_u32 s28, s28, 154368
    v_lshl_add_u32 v11, v0, 2, s28
    s_and_b32 s25, s2, 7
    s_lshl_b32 s25, s25, 2
    s_bfe_u32 s26, s2, 0x20003
    s_add_u32 s25, s25, s26
    s_lshr_b32 s38, s24, 2
    s_and_b32 s39, s24, 3
    s_lshr_b32 s26, s2, 5
    s_lshl_b32 s26, s26, 3
    s_lshl_b32 s28, s39, 1
    s_add_u32 s26, s26, s28
    s_mul_i32 s27, s25, 65536
    s_lshr_b32 s28, s39, 1
    s_mul_i32 s28, s28, 2097152
    s_add_u32 s30, s27, s28
    s_add_u32 s30, s30, 2097152
    s_lshl_b32 s28, s38, 15
    s_add_u32 s30, s30, s28
    s_and_b32 s28, s39, 1
    s_lshl_b32 s28, s28, 10
    s_add_u32 s30, s30, s28
    s_lshl_b32 s28, s24, 10
    s_lshl_b32 s32, s26, 10
    s_add_u32 s32, s32, s27
    s_add_u32 s32, s32, 0
    s_add_u32 s33, s27, 2097152
    s_mov_b32 m0, s28
    v_lshrrev_b32 v2, 5, v0
    v_lshlrev_b32 v2, 8, v2
    v_and_b32 v3, 15, v0
    v_lshl_add_u32 v2, v3, 4, v2
    s_lshl_b32 s29, s38, 12
    v_add_u32 v15, s29, v1
    v_bfe_u32 v10, v0, 4, 1
    v_add_u32 v10, -1, v10
    s_add_u32 s31, s29, 4294817024
    v_and_b32 v3, s31, v10
    v_add_u32 v3, 152320, v3
    v_add_u32 v3, v3, v2
    v_and_b32 v12, 3, v0
    v_lshlrev_b32 v12, 8, v12
    v_lshl_add_u32 v12, v0, 2, v12
    s_lshl_b32 s31, s38, 10
    s_add_u32 s31, s31, 154368
    v_add_u32 v12, s31, v12
    s_xor_b32 s31, s24, 4
    s_lshl_b32 s31, s31, 8
    s_add_u32 s31, s31, 154240
    s_mov_b32 exec_lo, 0
    v_lshl_add_u32 v12, v0, 2, s31
    s_mov_b32 exec_lo, -1
    s_mov_b32 s40, 0x0000ffff
    s_mov_b32 s41, 0x0000ffff
    v_mov_b32 v132, 0
    v_mov_b32 v133, 0
    v_mov_b32 v134, 0
    v_mov_b32 v135, 0
    v_mov_b32 v48, 0
    v_mov_b32 v49, 0
    v_mov_b32 v50, 0
    v_mov_b32 v51, 0
    v_mov_b32 v52, 0
    v_mov_b32 v53, 0
    v_mov_b32 v54, 0
    v_mov_b32 v55, 0
    v_mov_b32 v56, 0
    v_mov_b32 v57, 0
    v_mov_b32 v58, 0
    v_mov_b32 v59, 0
    v_mov_b32 v60, 0
    v_mov_b32 v61, 0
    v_mov_b32 v62, 0
    v_mov_b32 v63, 0
    v_mov_b32 v64, 0
    v_mov_b32 v65, 0
    v_mov_b32 v66, 0
    v_mov_b32 v67, 0
    v_mov_b32 v68, 0
    v_mov_b32 v69, 0
    v_mov_b32 v70, 0
    v_mov_b32 v71, 0
    v_mov_b32 v72, 0
    v_mov_b32 v73, 0
    v_mov_b32 v74, 0
    v_mov_b32 v75, 0
    v_mov_b32 v76, 0
    v_mov_b32 v77, 0
    v_mov_b32 v78, 0
    v_mov_b32 v79, 0
    v_mov_b32 v144, 0xdddddddd
    v_mov_b32 v5, v3
    v_add_u32 v6, 8192, v15
    v_and_b32 v7, 8192, v10
    v_add_u32 v7, v7, v3
    v_lshrrev_b32 v13, 5, v0
    v_add_u32 v13, 1, v13
    v_mov_b32 v142, 0
    s_waitcnt lgkmcnt(0)
    v_readfirstlane_b32 s70, v143
    s_mov_b64 exec, 1
    s_waitcnt vmcnt(0)
    buffer_store_dword v143, v142, s[20:23], s44 offen sc1
    s_lshl_b32 s28, s24, 2
    s_add_u32 s28, s28, 157520
    v_mov_b32 v140, s28
    v_mov_b32 v141, 0x100000
    ds_write_b32 v140, v141
    s_mov_b64 exec, -1
    s_lshr_b32 s45, s25, 1
    s_mul_i32 s45, s45, 8448
    s_add_u32 s45, s45, 23199744
    v_lshlrev_b32 v140, 7, v0
    v_mov_b32 v142, 157504
    s_cmp_ge_u32 s24, 4
    s_cbranch_scc1 AQ_NW
    s_mov_b64 exec, 0
    s_cmp_eq_u32 s24, 0
    s_cbranch_scc1 HOP_WA_0
    s_cmp_eq_u32 s24, 1
    s_cbranch_scc1 HOP_WB_0
    s_cmp_eq_u32 s24, 2
    s_cbranch_scc1 HOP_WC_0
    s_cmp_eq_u32 s24, 3
    s_cbranch_scc1 HOP_WD_0
AQ_WR:
    s_mov_b64 exec, -1
AQ_NW:
    s_cmp_lg_u32 s24, 4
    s_cbranch_scc1 AQ_REL
    s_mov_b32 s46, 0
AQ_POLL:
    buffer_load_dword v141, v140, s[20:23], s45 offen sc1
    s_waitcnt vmcnt(0)
    v_cmp_ne_u32 vcc, s70, v141
    s_nop 0
    s_cmp_eq_u64 vcc, 0
    s_cbranch_scc1 AQ_OUT
    s_mov_b64 exec, vcc
    s_sleep 4
    s_add_u32 s46, s46, 1
    s_cmp_lt_u32 s46, 0x100000
    s_cbranch_scc1 AQ_POLL
AQ_OUT:
    s_mov_b64 exec, -1
AQ_GO:
    v_mov_b32 v141, 1
    ds_write_b32 v142, v141
    s_branch AQ_DONE
AQ_REL:
    s_sleep 1
    ds_read_b32 v141, v142
    s_waitcnt lgkmcnt(0)
    v_cmp_eq_u32 vcc, 1, v141
    s_nop 0
    s_cmp_eq_u64 vcc, -1
    s_cbranch_scc0 AQ_REL
AQ_DONE:
HOP_WA_0:
    s_cbranch_execz HOP_WA_1
    buffer_load_dwordx4 v[104:107], v1, s[20:23], s32 offen sc1
    buffer_load_dwordx4 v[108:111], v1, s[20:23], s32 offen offset:1024 sc1
    buffer_load_dwordx4 v[136:139], v1, s[20:23], s33 offen sc1
    buffer_load_dwordx4 v1, s[20:23], s30 offen sc1 lds
    s_add_u32 m0, m0, 8192
    s_add_u32 s30, s30, 2048
    buffer_load_dwordx4 v1, s[20:23], s30 offen sc1 lds
    s_add_u32 m0, m0, 8192
    s_add_u32 s30, s30, 2048
    buffer_load_dwordx4 v1, s[20:23], s30 offen sc1 lds
    s_add_u32 m0, m0, 8192
    s_add_u32 s30, s30, 2048
    s_waitcnt vmcnt(3)
HOP_WA_1:
    s_cbranch_execz HOP_WA_2
    v_mfma_f32_32x32x16_bf16 v[16:31], v[136:139], v[104:107], 0
    v_mfma_f32_32x32x16_bf16 v[32:47], v[136:139], v[108:111], 0
    s_waitcnt vmcnt(1)
    ds_write_b32 v11, v13
    s_mov_b32 s34, 1
    s_nop 7
    v_max3_f32 v8, v16, v17, v18
    v_max3_f32 v8, v8, v19, v20
    v_max3_f32 v8, v8, v21, v22
    v_max3_f32 v8, v8, v23, v24
    v_max3_f32 v8, v8, v25, v26
    v_max3_f32 v8, v8, v27, v28
    v_max3_f32 v8, v8, v29, v30
    v_max3_f32 v8, v8, v31, v32
    v_max3_f32 v8, v8, v33, v34
HOP_WA_2:
    s_cbranch_execz HOP_WA_3
    v_max3_f32 v8, v8, v35, v36
    v_max3_f32 v8, v8, v37, v38
    v_max3_f32 v8, v8, v39, v40
    v_max3_f32 v8, v8, v41, v42
    v_max3_f32 v8, v8, v43, v44
    v_max3_f32 v8, v8, v45, v46
    v_max_f32 v8, v8, v47
    ds_read_b32 v14, v12
    v_mov_b32 v9, v8
    s_nop 1
    v_permlane32_swap_b32 v8, v9
    v_max_f32 v8, v8, v9
    v_xor_b32 v80, 0x80000000, v8
    v_xor_b32 v81, 0x80000000, v8
    v_xor_b32 v82, 0x80000000, v8
HOP_WA_3:
    s_cbranch_execz HOP_WA_4
    v_xor_b32 v83, 0x80000000, v8
    v_xor_b32 v84, 0x80000000, v8
    v_xor_b32 v85, 0x80000000, v8
    v_xor_b32 v86, 0x80000000, v8
    v_xor_b32 v87, 0x80000000, v8
    v_xor_b32 v88, 0x80000000, v8
    v_xor_b32 v89, 0x80000000, v8
    v_xor_b32 v90, 0x80000000, v8
    v_xor_b32 v91, 0x80000000, v8
    v_xor_b32 v92, 0x80000000, v8
    v_xor_b32 v93, 0x80000000, v8
    v_xor_b32 v94, 0x80000000, v8
    v_xor_b32 v95, 0x80000000, v8
HOP_WA_4:
    s_cbranch_execz HOP_WA_5
    v_mov_b32 v40, 0
    v_mov_b32 v41, 0
    v_mov_b32 v42, 0
    v_mov_b32 v43, 0
    v_mov_b32 v44, 0
    v_mov_b32 v45, 0
    v_mov_b32 v46, 0
    v_mov_b32 v47, 0
    s_waitcnt lgkmcnt(0)
    v_cmp_le_u32 vcc, v13, v14
    s_setprio 1
    s_cmp_eq_u32 vcc_lo, -1
    s_cbranch_scc0 AP_SPIN
AP_CONT:
    ds_read_b128 v[112:115], v15
    ds_read_b128 v[120:123], v5
    ds_read_b128 v[124:127], v5 offset:512
    ds_read_b128 v[116:119], v15 offset:1024
    s_mov_b32 s37, 16384
    s_waitcnt lgkmcnt(3)
HOP_WA_5:
    s_cbranch_execz HOP_WA_6
    v_mfma_f32_32x32x16_bf16 v[16:31], v[112:115], v[104:107], v[80:95]
    s_nop 10
HOP_WA_6:
    s_cbranch_execz AQ_WR
AT_LOOP:
HOP_WB_0:
    s_cbranch_execz HOP_WB_1
    v_exp_f32 v16, v16
    ds_read_b32 v14, v12
    v_exp_f32 v17, v17
    v_smfmac_f32_32x32x32_bf16 v[64:79], v[132:135], v[40:47], v144
    v_exp_f32 v18, v18
    ds_read_b128 v[128:131], v5 offset:1024
    v_exp_f32 v19, v19
    v_exp_f32 v20, v20
    ds_read_b128 v[132:135], v5 offset:1536
    v_exp_f32 v21, v21
    v_mfma_f32_32x32x16_bf16 v[32:47], v[112:115], v[108:111], v[80:95]
    v_exp_f32 v22, v22
    v_exp_f32 v23, v23
    v_exp_f32 v24, v24
    v_exp_f32 v25, v25
    v_exp_f32 v26, v26
    s_waitcnt lgkmcnt(2)
    v_smfmac_f32_32x32x32_bf16 v[48:63], v[120:123], v[16:23], v144
    v_exp_f32 v27, v27
HOP_WB_1:
    s_cbranch_execz HOP_WB_2
    v_cmp_le_u32 vcc, v13, v14
    v_exp_f32 v28, v28
    s_setprio 1
    v_exp_f32 v29, v29
    s_cmp_eq_u32 vcc_lo, -1
    s_cbranch_scc0 AT0_SPIN
AT0_CONT:
    v_add_u32 v13, 1, v13
    s_cmp_eq_u32 vcc_hi, 0
    s_cbranch_scc1 AT0_AHEAD
    s_setprio 2
AT0_AHEAD:
    v_exp_f32 v30, v30
    v_exp_f32 v31, v31
    v_exp_f32 v32, v32
    s_waitcnt vmcnt(0)
    v_exp_f32 v33, v33
    ds_write_b32 v11, v13
    v_smfmac_f32_32x32x32_bf16 v[48:63], v[124:127], v[24:31], v144
    v_exp_f32 v34, v34
    ds_read_b128 v[112:115], v6 offset:0
    v_exp_f32 v35, v35
    s_cmp_ge_u32 s34, 14
    v_exp_f32 v36, v36
HOP_WB_2:
    s_cbranch_execz HOP_WB_3
    v_exp_f32 v37, v37
    s_waitcnt lgkmcnt(5)
    v_mfma_f32_32x32x16_bf16 v[16:31], v[116:119], v[104:107], v[80:95]
    s_cbranch_scc1 AT_NODMA0
    buffer_load_dwordx4 v1, s[20:23], s30 offen sc1 lds
AT_NODMA0:
    v_exp_f32 v38, v38
    s_add_u32 s35, m0, 8192
    v_exp_f32 v39, v39
    s_and_b32 m0, s35, 0xffff
    v_exp_f32 v40, v40
    s_add_u32 s30, s30, 2048
    v_exp_f32 v41, v41
    v_exp_f32 v42, v42
    v_smfmac_f32_32x32x32_bf16 v[64:79], v[120:123], v[32:39], v144
    v_exp_f32 v43, v43
    v_exp_f32 v44, v44
    v_exp_f32 v45, v45
    v_exp_f32 v46, v46
    v_exp_f32 v47, v47
    v_exp_f32 v16, v16
HOP_WB_3:
    s_cbranch_execz HOP_WB_4
    v_exp_f32 v17, v17
    v_smfmac_f32_32x32x32_bf16 v[64:79], v[124:127], v[40:47], v144
    v_exp_f32 v18, v18
    ds_read_b128 v[120:123], v7 offset:0
    v_exp_f32 v19, v19
    v_exp_f32 v20, v20
    ds_read_b128 v[124:127], v7 offset:512
    v_exp_f32 v21, v21
    v_mfma_f32_32x32x16_bf16 v[32:47], v[116:119], v[108:111], v[80:95]
    v_exp_f32 v22, v22
    v_exp_f32 v23, v23
    v_exp_f32 v24, v24
    v_exp_f32 v25, v25
    v_exp_f32 v26, v26
    s_waitcnt lgkmcnt(4)
    v_smfmac_f32_32x32x32_bf16 v[48:63], v[128:131], v[16:23], v144
    v_exp_f32 v27, v27
    v_exp_f32 v28, v28
    v_exp_f32 v29, v29
    v_exp_f32 v30, v30
    v_exp_f32 v31, v31
HOP_WB_4:
    s_cbranch_execz HOP_WB_5
    v_exp_f32 v32, v32
    v_exp_f32 v33, v33
    v_smfmac_f32_32x32x32_bf16 v[48:63], v[132:135], v[24:31], v144
    v_exp_f32 v34, v34
    ds_read_b128 v[116:119], v6 offset:1024
    v_exp_f32 v35, v35
    v_exp_f32 v36, v36
    v_exp_f32 v37, v37
    s_waitcnt lgkmcnt(3)
    v_mfma_f32_32x32x16_bf16 v[16:31], v[112:115], v[104:107], v[80:95]
    v_exp_f32 v38, v38
    s_add_u32 s34, s34, 1
    v_exp_f32 v39, v39
    v_exp_f32 v40, v40
    v_exp_f32 v41, v41
    v_exp_f32 v42, v42
    v_smfmac_f32_32x32x32_bf16 v[64:79], v[128:131], v[32:39], v144
    v_mov_b32 v5, v7
    v_add_u32 v6, s37, v15
    v_and_b32 v7, s37, v10
    v_add_u32 v7, v7, v3
    v_exp_f32 v43, v43
HOP_WB_5:
    s_cbranch_execz HOP_WB_6
    s_add_u32 s37, s37, 8192
    v_exp_f32 v44, v44
    s_and_b32 s37, s37, 0xffff
    v_exp_f32 v45, v45
    s_cmp_lt_u32 s34, 17
    v_exp_f32 v46, v46
    v_exp_f32 v47, v47
HOP_WB_6:
    s_cbranch_execz AQ_WR
HOP_WC_0:
    s_cbranch_execz HOP_WC_1
    v_exp_f32 v16, v16
    ds_read_b32 v14, v12
    v_exp_f32 v17, v17
    v_smfmac_f32_32x32x32_bf16 v[64:79], v[132:135], v[40:47], v144
    v_exp_f32 v18, v18
    ds_read_b128 v[128:131], v5 offset:1024
    v_exp_f32 v19, v19
    v_exp_f32 v20, v20
    ds_read_b128 v[132:135], v5 offset:1536
    v_exp_f32 v21, v21
    v_mfma_f32_32x32x16_bf16 v[32:47], v[112:115], v[108:111], v[80:95]
    v_exp_f32 v22, v22
    v_exp_f32 v23, v23
    v_exp_f32 v24, v24
    v_exp_f32 v25, v25
    v_exp_f32 v26, v26
    s_waitcnt lgkmcnt(2)
    v_smfmac_f32_32x32x32_bf16 v[48:63], v[120:123], v[16:23], v144
    v_exp_f32 v27, v27
HOP_WC_1:
    s_cbranch_execz HOP_WC_2
    v_cmp_le_u32 vcc, v13, v14
    v_exp_f32 v28, v28
    s_setprio 1
    v_exp_f32 v29, v29
    s_cmp_eq_u32 vcc_lo, -1
    s_cbranch_scc0 AT1_SPIN
AT1_CONT:
    v_add_u32 v13, 1, v13
    s_cmp_eq_u32 vcc_hi, 0
    s_cbranch_scc1 AT1_AHEAD
    s_setprio 2
AT1_AHEAD:
    v_exp_f32 v30, v30
    v_exp_f32 v31, v31
    v_exp_f32 v32, v32
    s_waitcnt vmcnt(0)
    v_exp_f32 v33, v33
    ds_write_b32 v11, v13
    v_smfmac_f32_32x32x32_bf16 v[48:63], v[124:127], v[24:31], v144
    v_exp_f32 v34, v34
    ds_read_b128 v[112:115], v6 offset:0
    v_exp_f32 v35, v35
    s_cmp_ge_u32 s34, 14
    v_exp_f32 v36, v36
HOP_WC_2:
    s_cbranch_execz HOP_WC_3
    v_exp_f32 v37, v37
    s_waitcnt lgkmcnt(5)
    v_mfma_f32_32x32x16_bf16 v[16:31], v[116:119], v[104:107], v[80:95]
    s_cbranch_scc1 AT_NODMA1
    buffer_load_dwordx4 v1, s[20:23], s30 offen sc1 lds
AT_NODMA1:
    v_exp_f32 v38, v38
    s_add_u32 s35, m0, 8192
    v_exp_f32 v39, v39
    s_and_b32 m0, s35, 0xffff
    v_exp_f32 v40, v40
    s_add_u32 s30, s30, 2048
    v_exp_f32 v41, v41
    v_exp_f32 v42, v42
    v_smfmac_f32_32x32x32_bf16 v[64:79], v[120:123], v[32:39], v144
    v_exp_f32 v43, v43
    v_exp_f32 v44, v44
    v_exp_f32 v45, v45
    v_exp_f32 v46, v46
    v_exp_f32 v47, v47
    v_exp_f32 v16, v16
HOP_WC_3:
    s_cbranch_execz HOP_WC_4
    v_exp_f32 v17, v17
    v_smfmac_f32_32x32x32_bf16 v[64:79], v[124:127], v[40:47], v144
    v_exp_f32 v18, v18
    ds_read_b128 v[120:123], v7 offset:0
    v_exp_f32 v19, v19
    v_exp_f32 v20, v20
    ds_read_b128 v[124:127], v7 offset:512
    v_exp_f32 v21, v21
    v_mfma_f32_32x32x16_bf16 v[32:47], v[116:119], v[108:111], v[80:95]
    v_exp_f32 v22, v22
    v_exp_f32 v23, v23
    v_exp_f32 v24, v24
    v_exp_f32 v25, v25
    v_exp_f32 v26, v26
    s_waitcnt lgkmcnt(4)
    v_smfmac_f32_32x32x32_bf16 v[48:63], v[128:131], v[16:23], v144
    v_exp_f32 v27, v27
    v_exp_f32 v28, v28
    v_exp_f32 v29, v29
    v_exp_f32 v30, v30
    v_exp_f32 v31, v31
HOP_WC_4:
    s_cbranch_execz HOP_WC_5
    v_exp_f32 v32, v32
    v_exp_f32 v33, v33
    v_smfmac_f32_32x32x32_bf16 v[48:63], v[132:135], v[24:31], v144
    v_exp_f32 v34, v34
    ds_read_b128 v[116:119], v6 offset:1024
    v_exp_f32 v35, v35
    v_exp_f32 v36, v36
    v_exp_f32 v37, v37
    s_waitcnt lgkmcnt(3)
    v_mfma_f32_32x32x16_bf16 v[16:31], v[112:115], v[104:107], v[80:95]
    v_exp_f32 v38, v38
    s_add_u32 s34, s34, 1
    v_exp_f32 v39, v39
    v_exp_f32 v40, v40
    v_exp_f32 v41, v41
    v_exp_f32 v42, v42
    v_smfmac_f32_32x32x32_bf16 v[64:79], v[128:131], v[32:39], v144
    v_mov_b32 v5, v7
    v_add_u32 v6, s37, v15
    v_and_b32 v7, s37, v10
    v_add_u32 v7, v7, v3
    v_exp_f32 v43, v43
HOP_WC_5:
    s_cbranch_execz HOP_WC_6
    s_add_u32 s37, s37, 8192
    v_exp_f32 v44, v44
    s_and_b32 s37, s37, 0xffff
    v_exp_f32 v45, v45
    s_cmp_lt_u32 s34, 17
    v_exp_f32 v46, v46
    v_exp_f32 v47, v47
HOP_WC_6:
    s_cbranch_execz AQ_WR
    s_cbranch_scc1 AT_LOOP
HOP_WD_0:
    s_cbranch_execz HOP_WD_1
    v_smfmac_f32_32x32x32_bf16 v[64:79], v[132:135], v[40:47], v144
    s_lshl_b32 s35, s39, 13
    v_add_u32 v4, s35, v15
    v_xor_b32 v5, 4096, v4
    s_lshl_b32 s35, s39, 9
    s_add_u32 s35, s35, s29
    s_add_u32 s35, s35, 32768
    v_lshl_add_u32 v6, v0, 2, s35
    v_xor_b32 v7, 4096, v6
    s_lshl_b32 s35, s39, 2
    s_add_u32 s35, s35, 157440
    v_mov_b32 v8, s35
    v_mov_b32 v9, 1
    ds_write_b128 v4, v[48:51] offset:0
    ds_write_b128 v4, v[52:55] offset:1024
    ds_write_b32 v6, v56 offset:0
HOP_WD_1:
    s_cbranch_execz HOP_WD_2
    ds_write_b128 v4, v[64:67] offset:2048
    ds_write_b128 v4, v[68:71] offset:3072
    ds_write_b32 v6, v72 offset:256
    s_mov_b64 exec, 1
    ds_add_rtn_u32 v9, v8, v9
    s_mov_b64 exec, -1
    ds_read_b128 v[16:19], v5 offset:0
    ds_read_b128 v[20:23], v5 offset:1024
    ds_read_b32 v24, v7 offset:0
    ds_read_b128 v[32:35], v5 offset:2048
    ds_read_b128 v[36:39], v5 offset:3072
    ds_read_b32 v40, v7 offset:256
    s_lshl_b32 s33, s26, 15
    s_lshl_b32 s34, s25, 10
    s_add_u32 s33, s33, s34
HOP_WD_2:
    s_cbranch_execz HOP_WD_3
    s_add_u32 s33, s33, 16777216
    v_mov_b32 v11, 0x4e800000
    v_mov_b32 v10, 0x30800000
    v_mov_b32 v14, 0x7f800000
    s_waitcnt lgkmcnt(0)
    v_readfirstlane_b32 s35, v9
    s_nop 0
    s_cmp_eq_u32 s35, 0
    s_cbranch_scc1 AT_EXIT
    v_add_f32 v48, v48, v16
    v_add_f32 v49, v49, v17
    v_add_f32 v50, v50, v18
    v_add_f32 v51, v51, v19
    v_add_f32 v52, v52, v20
    v_add_f32 v53, v53, v21
    v_add_f32 v54, v54, v22
    v_add_f32 v55, v55, v23
    v_add_f32 v56, v56, v24
    v_add_f32 v64, v64, v32
    v_add_f32 v65, v65, v33
    v_add_f32 v66, v66, v34
    v_add_f32 v67, v67, v35
    v_add_f32 v68, v68, v36
HOP_WD_3:
    s_cbranch_execz HOP_WD_4
    v_add_f32 v69, v69, v37
    v_add_f32 v70, v70, v38
    v_add_f32 v71, v71, v39
    v_add_f32 v72, v72, v40
    v_add_f32 v8, |v48|, |v64|
    v_add_f32 v8, v8, |v49|
    v_add_f32 v8, v8, |v50|
    v_add_f32 v8, v8, |v51|
    v_add_f32 v8, v8, |v52|
    v_add_f32 v8, v8, |v53|
    v_add_f32 v8, v8, |v54|
    v_add_f32 v8, v8, |v55|
    v_add_f32 v8, v8, |v65|
    v_add_f32 v8, v8, |v66|
    v_add_f32 v8, v8, |v67|
HOP_WD_4:
    s_cbranch_execz HOP_WD_5
    v_add_f32 v8, v8, |v68|
    v_add_f32 v8, v8, |v69|
    v_add_f32 v8, v8, |v70|
    v_add_f32 v8, v8, |v71|
    v_cmp_gt_f32 s[42:43], v14, v8
    v_cmp_gt_f32 s[44:45], v11, v56
    v_cmp_lt_f32 s[46:47], v10, v56
    s_and_b64 s[42:43], s[42:43], s[44:45]
    s_and_b64 s[42:43], s[42:43], s[46:47]
    v_cmp_gt_f32 s[44:45], v11, v72
    v_cmp_lt_f32 s[46:47], v10, v72
    s_and_b64 s[42:43], s[42:43], s[44:45]
    s_and_b64 s[42:43], s[42:43], s[46:47]
    s_cmp_eq_u64 s[42:43], -1
    s_cbranch_scc0 AT_SLOW
AT_FIN:
    s_add_u32 s34, s33, 32768
HOP_WD_5:
    s_cbranch_execz HOP_WD_6
    v_rcp_f32 v8, v56
    v_rcp_f32 v9, v72
    v_mul_f32 v48, v8, v48
    v_mul_f32 v49, v8, v49
    v_mul_f32 v50, v8, v50
    v_mul_f32 v51, v8, v51
    v_mul_f32 v52, v8, v52
    v_mul_f32 v53, v8, v53
    v_mul_f32 v54, v8, v54
    v_mul_f32 v55, v8, v55
    v_cvt_pk_bf16_f32 v96, v48, v49
    v_cvt_pk_bf16_f32 v97, v50, v51
    v_cvt_pk_bf16_f32 v98, v52, v53
    v_cvt_pk_bf16_f32 v99, v54, v55
    buffer_store_dwordx4 v[96:99], v1, s[20:23], s33 offen sc1
    v_mul_f32 v64, v9, v64
    v_mul_f32 v65, v9, v65
    v_mul_f32 v66, v9, v66
    v_mul_f32 v67, v9, v67
    v_mul_f32 v68, v9, v68
    v_mul_f32 v69, v9, v69
HOP_WD_6:
    s_cbranch_execz HOP_WD_7
    v_mul_f32 v70, v9, v70
    v_mul_f32 v71, v9, v71
    v_cvt_pk_bf16_f32 v100, v64, v65
    v_cvt_pk_bf16_f32 v101, v66, v67
    v_cvt_pk_bf16_f32 v102, v68, v69
    v_cvt_pk_bf16_f32 v103, v70, v71
    buffer_store_dwordx4 v[100:103], v1, s[20:23], s34 offen sc1
    s_lshl_b32 s35, s26, 5
    s_add_u32 s35, s35, s25
    s_lshl_b32 s35, s35, 2
    s_add_u32 s35, s35, 23101440
    v_mov_b32 v8, 0
    v_mov_b32 v9, s70
    s_mov_b64 exec, 1
    s_waitcnt vmcnt(0)
    buffer_store_dword v9, v8, s[20:23], s35 offen sc1
    s_mov_b64 exec, -1
HOP_WD_7:
    s_cbranch_execz AQ_WR
AT_EXIT:
    s_endpgm
AP_SPIN:
    s_sleep 1
    ds_read_b32 v14, v12
    s_waitcnt lgkmcnt(0)
    v_cmp_le_u32 vcc, v13, v14
    s_nop 0
    s_cmp_eq_u32 vcc_lo, -1
    s_cbranch_scc0 AP_SPIN
    s_branch AP_CONT
AT0_SPIN:
    s_sleep 1
    ds_read_b32 v14, v12
    s_waitcnt lgkmcnt(0)
    v_cmp_le_u32 vcc, v13, v14
    s_nop 0
    s_cmp_eq_u32 vcc_lo, -1
    s_cbranch_scc0 AT0_SPIN
    s_branch AT0_CONT
AT1_SPIN:
    s_sleep 1
    ds_read_b32 v14, v12
    s_waitcnt lgkmcnt(0)
    v_cmp_le_u32 vcc, v13, v14
    s_nop 0
    s_cmp_eq_u32 vcc_lo, -1
    s_cbranch_scc0 AT1_SPIN
    s_branch AT1_CONT
AT_SLOW:
    s_add_u32 s30, s27, 2097152
    s_add_u32 s31, s27, 4194304
    v_mov_b32 v120, 0x3f803f80
    v_mov_b32 v121, 0x3f803f80
    v_mov_b32 v122, 0x3f803f80
    v_mov_b32 v123, 0x3f803f80
    v_mov_b32 v124, 0x3f803f80
    v_mov_b32 v125, 0x3f803f80
    v_mov_b32 v126, 0x3f803f80
    v_mov_b32 v127, 0x3f803f80
    v_mov_b32 v8, 0xff800000
    s_mov_b32 s34, 0
AT_S10:
    s_add_u32 s36, s30, s34
    buffer_load_dwordx4 v[112:115], v1, s[20:23], s36 offen sc1
    s_waitcnt vmcnt(0)
    v_mfma_f32_32x32x16_bf16 v[16:31], v[112:115], v[104:107], 0
    s_nop 11
    v_max3_f32 v8, v8, v16, v17
    v_max3_f32 v8, v8, v18, v19
    v_max3_f32 v8, v8, v20, v21
    v_max3_f32 v8, v8, v22, v23
    v_max3_f32 v8, v8, v24, v25
    v_max3_f32 v8, v8, v26, v27
    v_max3_f32 v8, v8, v28, v29
    v_max3_f32 v8, v8, v30, v31
    s_add_u32 s34, s34, 1024
    s_cmp_lt_u32 s34, 65536
    s_cbranch_scc1 AT_S10
    v_mov_b32 v9, v8
    s_nop 1
    v_permlane32_swap_b32 v8, v9
    v_max_f32 v8, v8, v9
    v_xor_b32 v80, 0x80000000, v8
    v_xor_b32 v81, 0x80000000, v8
    v_xor_b32 v82, 0x80000000, v8
    v_xor_b32 v83, 0x80000000, v8
    v_xor_b32 v84, 0x80000000, v8
    v_xor_b32 v85, 0x80000000, v8
    v_xor_b32 v86, 0x80000000, v8
    v_xor_b32 v87, 0x80000000, v8
    v_xor_b32 v88, 0x80000000, v8
    v_xor_b32 v89, 0x80000000, v8
    v_xor_b32 v90, 0x80000000, v8
    v_xor_b32 v91, 0x80000000, v8
    v_xor_b32 v92, 0x80000000, v8
    v_xor_b32 v93, 0x80000000, v8
    v_xor_b32 v94, 0x80000000, v8
    v_xor_b32 v95, 0x80000000, v8
    v_mov_b32 v48, 0
    v_mov_b32 v49, 0
    v_mov_b32 v50, 0
    v_mov_b32 v51, 0
    v_mov_b32 v52, 0
    v_mov_b32 v53, 0
    v_mov_b32 v54, 0
    v_mov_b32 v55, 0
    v_mov_b32 v56, 0
    v_mov_b32 v57, 0
    v_mov_b32 v58, 0
    v_mov_b32 v59, 0
    v_mov_b32 v60, 0
    v_mov_b32 v61, 0
    v_mov_b32 v62, 0
    v_mov_b32 v63, 0
    s_mov_b32 s34, 0
AT_S20:
    s_add_u32 s36, s30, s34
    s_add_u32 s35, s31, s34
    buffer_load_dwordx4 v[112:115], v1, s[20:23], s36 offen sc1
    s_mov_b64 exec, s[40:41]
    buffer_load_dwordx4 v[120:123], v2, s[20:23], s35 offen sc1
    buffer_load_dwordx4 v[124:127], v2, s[20:23], s35 offen offset:512 sc1
    s_mov_b64 exec, -1
    s_waitcnt vmcnt(0)
    v_mfma_f32_32x32x16_bf16 v[16:31], v[112:115], v[104:107], v[80:95]
    s_nop 11
    v_exp_f32 v16, v16
    v_exp_f32 v17, v17
    v_exp_f32 v18, v18
    v_exp_f32 v19, v19
    v_exp_f32 v20, v20
    v_exp_f32 v21, v21
    v_exp_f32 v22, v22
    v_exp_f32 v23, v23
    v_exp_f32 v24, v24
    v_exp_f32 v25, v25
    v_exp_f32 v26, v26
    v_exp_f32 v27, v27
    v_exp_f32 v28, v28
    v_exp_f32 v29, v29
    v_exp_f32 v30, v30
    v_exp_f32 v31, v31
    v_smfmac_f32_32x32x32_bf16 v[48:63], v[120:123], v[16:23], v144
    s_nop 0
    v_smfmac_f32_32x32x32_bf16 v[48:63], v[124:127], v[24:31], v144
    s_nop 15
    s_add_u32 s34, s34, 1024
    s_cmp_lt_u32 s34, 65536
    s_cbranch_scc1 AT_S20
    v_mov_b32 v8, 0xff800000
    s_mov_b32 s34, 0
AT_S11:
    s_add_u32 s36, s30, s34
    buffer_load_dwordx4 v[112:115], v1, s[20:23], s36 offen sc1
    s_waitcnt vmcnt(0)
    v_mfma_f32_32x32x16_bf16 v[16:31], v[112:115], v[108:111], 0
    s_nop 11
    v_max3_f32 v8, v8, v16, v17
    v_max3_f32 v8, v8, v18, v19
    v_max3_f32 v8, v8, v20, v21
    v_max3_f32 v8, v8, v22, v23
    v_max3_f32 v8, v8, v24, v25
    v_max3_f32 v8, v8, v26, v27
    v_max3_f32 v8, v8, v28, v29
    v_max3_f32 v8, v8, v30, v31
    s_add_u32 s34, s34, 1024
    s_cmp_lt_u32 s34, 65536
    s_cbranch_scc1 AT_S11
    v_mov_b32 v9, v8
    s_nop 1
    v_permlane32_swap_b32 v8, v9
    v_max_f32 v8, v8, v9
    v_xor_b32 v80, 0x80000000, v8
    v_xor_b32 v81, 0x80000000, v8
    v_xor_b32 v82, 0x80000000, v8
    v_xor_b32 v83, 0x80000000, v8
    v_xor_b32 v84, 0x80000000, v8
    v_xor_b32 v85, 0x80000000, v8
    v_xor_b32 v86, 0x80000000, v8
    v_xor_b32 v87, 0x80000000, v8
    v_xor_b32 v88, 0x80000000, v8
    v_xor_b32 v89, 0x80000000, v8
    v_xor_b32 v90, 0x80000000, v8
    v_xor_b32 v91, 0x80000000, v8
    v_xor_b32 v92, 0x80000000, v8
    v_xor_b32 v93, 0x80000000, v8
    v_xor_b32 v94, 0x80000000, v8
    v_xor_b32 v95, 0x80000000, v8
    v_mov_b32 v64, 0
    v_mov_b32 v65, 0
    v_mov_b32 v66, 0
    v_mov_b32 v67, 0
    v_mov_b32 v68, 0
    v_mov_b32 v69, 0
    v_mov_b32 v70, 0
    v_mov_b32 v71, 0
    v_mov_b32 v72, 0
    v_mov_b32 v73, 0
    v_mov_b32 v74, 0
    v_mov_b32 v75, 0
    v_mov_b32 v76, 0
    v_mov_b32 v77, 0
    v_mov_b32 v78, 0
    v_mov_b32 v79, 0
    s_mov_b32 s34, 0
AT_S21:
    s_add_u32 s36, s30, s34
    s_add_u32 s35, s31, s34
    buffer_load_dwordx4 v[112:115], v1, s[20:23], s36 offen sc1
    s_mov_b64 exec, s[40:41]
    buffer_load_dwordx4 v[120:123], v2, s[20:23], s35 offen sc1
    buffer_load_dwordx4 v[124:127], v2, s[20:23], s35 offen offset:512 sc1
    s_mov_b64 exec, -1
    s_waitcnt vmcnt(0)
    v_mfma_f32_32x32x16_bf16 v[16:31], v[112:115], v[108:111], v[80:95]
    s_nop 11
    v_exp_f32 v16, v16
    v_exp_f32 v17, v17
    v_exp_f32 v18, v18
    v_exp_f32 v19, v19
    v_exp_f32 v20, v20
    v_exp_f32 v21, v21
    v_exp_f32 v22, v22
    v_exp_f32 v23, v23
    v_exp_f32 v24, v24
    v_exp_f32 v25, v25
    v_exp_f32 v26, v26
    v_exp_f32 v27, v27
    v_exp_f32 v28, v28
    v_exp_f32 v29, v29
    v_exp_f32 v30, v30
    v_exp_f32 v31, v31
    v_smfmac_f32_32x32x32_bf16 v[64:79], v[120:123], v[16:23], v144
    s_nop 0
    v_smfmac_f32_32x32x32_bf16 v[64:79], v[124:127], v[24:31], v144
    s_nop 15
    s_add_u32 s34, s34, 1024
    s_cmp_lt_u32 s34, 65536
    s_cbranch_scc1 AT_S21
    s_branch AT_FIN
M_GEMM:
    s_waitcnt lgkmcnt(0)
    s_setprio 3
    s_sub_u32 s25, s24, 8
    s_mov_b32 s16, s4
    s_and_b32 s17, s5, 0xffff
    s_mov_b32 s18, 2097152
    s_mov_b32 s19, 0x20000
    s_mov_b32 s20, s8
    s_and_b32 s21, s9, 0xffff
    s_mov_b32 s22, 33554432
    s_mov_b32 s23, 0x20000
    v_lshrrev_b32 v42, 3, v0
    v_lshlrev_b32 v15, 10, v42
    v_and_b32 v45, 7, v0
    v_lshl_add_u32 v15, v45, 4, v15
    s_lshl_b32 s28, s2, 13
    s_lshl_b32 s29, s25, 8
    s_add_u32 s28, s28, s29
    buffer_load_dwordx4 v[16:19], v15, s[16:19], s28 offen
    buffer_load_dwordx4 v[20:23], v15, s[16:19], s28 offen offset:128
    v_mov_b32 v13, 0
    s_mov_b32 s28, 23138304
    buffer_load_dword v46, v13, s[20:23], s28 offen sc1
    s_mov_b32 s50, s4
    s_mov_b32 s51, s5
    s_load_dwordx4 s[4:7], s[0:1], 32
    s_load_dwordx2 s[48:49], s[0:1], 48
    s_load_dwordx2 s[56:57], s[0:1], 16
    s_load_dwordx2 s[58:59], s[0:1], 56
    v_lshlrev_b32 v43, 5, v42
    v_add_u32 v43, 161792, v43
    s_lshl_b32 s28, s25, 3
    v_add_u32 v44, s28, v43
    v_lshlrev_b32 v45, 9, v45
    v_lshl_add_u32 v45, v42, 4, v45
    s_barrier
    s_waitcnt vmcnt(1)
    v_lshlrev_b32 v24, 16, v16
    v_and_b32 v25, 0xffff0000, v16
    v_lshlrev_b32 v26, 16, v17
    v_and_b32 v27, 0xffff0000, v17
    v_lshlrev_b32 v28, 16, v18
    v_and_b32 v29, 0xffff0000, v18
    v_lshlrev_b32 v30, 16, v19
    v_and_b32 v31, 0xffff0000, v19
    v_lshlrev_b32 v32, 16, v20
    v_and_b32 v33, 0xffff0000, v20
    v_lshlrev_b32 v34, 16, v21
    v_and_b32 v35, 0xffff0000, v21
    v_lshlrev_b32 v36, 16, v22
    v_and_b32 v37, 0xffff0000, v22
    v_lshlrev_b32 v38, 16, v23
    v_and_b32 v39, 0xffff0000, v23
    v_add_f32 v40, v24, v25
    v_mul_f32 v41, v24, v24
    v_fmac_f32 v41, v25, v25
    v_add_f32 v40, v40, v26
    v_fmac_f32 v41, v26, v26
    v_add_f32 v40, v40, v27
    v_fmac_f32 v41, v27, v27
    v_add_f32 v40, v40, v28
    v_fmac_f32 v41, v28, v28
    v_add_f32 v40, v40, v29
    v_fmac_f32 v41, v29, v29
    v_add_f32 v40, v40, v30
    v_fmac_f32 v41, v30, v30
    v_add_f32 v40, v40, v31
    v_fmac_f32 v41, v31, v31
    v_add_f32 v40, v40, v32
    v_fmac_f32 v41, v32, v32
    v_add_f32 v40, v40, v33
    v_fmac_f32 v41, v33, v33
    v_add_f32 v40, v40, v34
    v_fmac_f32 v41, v34, v34
    v_add_f32 v40, v40, v35
    v_fmac_f32 v41, v35, v35
    v_add_f32 v40, v40, v36
    v_fmac_f32 v41, v36, v36
    v_add_f32 v40, v40, v37
    v_fmac_f32 v41, v37, v37
    v_add_f32 v40, v40, v38
    v_fmac_f32 v41, v38, v38
    v_add_f32 v40, v40, v39
    v_fmac_f32 v41, v39, v39
    s_nop 0
    v_add_f32_dpp v40, v40, v40 quad_perm:[1,0,3,2] row_mask:0xf bank_mask:0xf
    v_add_f32_dpp v41, v41, v41 quad_perm:[1,0,3,2] row_mask:0xf bank_mask:0xf
    s_nop 0
    v_add_f32_dpp v40, v40, v40 quad_perm:[2,3,0,1] row_mask:0xf bank_mask:0xf
    v_add_f32_dpp v41, v41, v41 quad_perm:[2,3,0,1] row_mask:0xf bank_mask:0xf
    s_nop 0
    v_add_f32_dpp v40, v40, v40 row_half_mirror row_mask:0xf bank_mask:0xf
    v_add_f32_dpp v41, v41, v41 row_half_mirror row_mask:0xf bank_mask:0xf
    ds_write_b64 v44, v[40:41]
    s_waitcnt lgkmcnt(0)
    s_barrier
    ds_read_b128 v[16:19], v43
    ds_read_b128 v[20:23], v43 offset:16
    v_mov_b32 v44, 0xffff0000
    s_lshr_b32 s28, s2, 2
    s_lshl_b32 s28, s28, 15
    s_and_b32 s29, s2, 3
    s_lshl_b32 s29, s29, 7
    s_add_u32 s28, s28, s29
    s_lshl_b32 s29, s25, 13
    s_add_u32 s28, s28, s29
    s_add_u32 s40, s28, 6291456
    s_add_u32 s41, s40, 4096
    s_waitcnt lgkmcnt(0)
    v_add_f32 v16, v16, v18
    v_add_f32 v17, v17, v19
    v_add_f32 v20, v20, v22
    v_add_f32 v21, v21, v23
    v_add_f32 v40, v16, v20
    v_add_f32 v41, v17, v21
    v_mul_f32 v40, 0x3b000000, v40
    v_mul_f32 v41, 0x3b000000, v41
    v_fma_f32 v41, -v40, v40, v41
    v_max_f32 v41, 0, v41
    v_cvt_pk_bf16_f32 v40, v40, v41
    v_and_b32 v41, v44, v40
    v_lshlrev_b32 v43, 16, v40
    v_add_f32 v41, 0x3727c5ac, v41
    v_cvt_pk_bf16_f32 v41, v41, v41
    v_lshlrev_b32 v41, 16, v41
    v_sqrt_f32 v41, v41
    s_nop 0
    v_cvt_pk_bf16_f32 v41, v41, v41
    v_lshlrev_b32 v41, 16, v41
    v_rcp_f32 v42, v41
    s_nop 0
    v_mul_f32 v43, -v43, v42
    s_barrier
    v_fma_f32 v24, v24, v42, v43
    v_fma_f32 v25, v25, v42, v43
    v_fma_f32 v26, v26, v42, v43
    v_fma_f32 v27, v27, v42, v43
    v_fma_f32 v28, v28, v42, v43
    v_fma_f32 v29, v29, v42, v43
    v_fma_f32 v30, v30, v42, v43
    v_fma_f32 v31, v31, v42, v43
    v_fma_f32 v32, v32, v42, v43
    v_fma_f32 v33, v33, v42, v43
    v_fma_f32 v34, v34, v42, v43
    v_fma_f32 v35, v35, v42, v43
    v_fma_f32 v36, v36, v42, v43
    v_fma_f32 v37, v37, v42, v43
    v_fma_f32 v38, v38, v42, v43
    v_fma_f32 v39, v39, v42, v43
    v_cvt_pk_bf16_f32 v16, v24, v25
    v_cvt_pk_bf16_f32 v17, v26, v27
    v_cvt_pk_bf16_f32 v18, v28, v29
    v_cvt_pk_bf16_f32 v19, v30, v31
    v_cvt_pk_bf16_f32 v20, v32, v33
    v_cvt_pk_bf16_f32 v21, v34, v35
    v_cvt_pk_bf16_f32 v22, v36, v37
    v_cvt_pk_bf16_f32 v23, v38, v39
    buffer_store_dwordx4 v[16:19], v45, s[20:23], s40 offen sc1
    buffer_store_dwordx4 v[20:23], v45, s[20:23], s41 offen sc1
    s_barrier
    v_lshlrev_b32 v1, 4, v0
    s_lshl_b32 s28, s24, 8
    s_add_u32 s28, s28, 154368
    v_lshl_add_u32 v11, v0, 2, s28
    v_mov_b32 v14, 0x3f803f80
    v_and_b32 v2, 44, v0
    v_cmp_eq_u32 vcc, 0, v2
    s_nop 1
    v_cndmask_b32 v14, 0, v14, vcc
    ds_write_b32 v11, v13
    v_add_u32 v2, -1024, v11
    ds_write_b32 v2, v13
    v_add_u32 v2, -2048, v11
    ds_write_b32 v2, v13
    v_lshlrev_b32 v2, 2, v0
    v_add_u32 v2, 157440, v2
    ds_write_b32 v2, v13
    v_add_u32 v2, -4096, v11
    ds_write_b32 v2, v14
    ds_write_b32 v2, v14 offset:1024
    s_mov_b32 s60, 0x7fffffff
    s_and_b32 s27, s2, 7
    s_lshr_b32 s62, s2, 5
    s_lshl_b32 s52, s62, 1
    s_lshr_b32 s29, s27, 2
    s_add_u32 s52, s52, s29
    s_and_b32 s26, s27, 3
    s_lshl_b32 s26, s26, 2
    s_bfe_u32 s29, s2, 0x20003
    s_add_u32 s26, s26, s29
    s_lshl_b32 s30, s52, 2
    s_add_u32 s30, s30, s25
    s_and_b32 s31, s25, 1
    s_cmp_lt_u32 s25, 2
    s_cselect_b32 s10, s4, s6
    s_cselect_b32 s11, s5, s7
    s_mov_b32 s12, s10
    s_and_b32 s13, s11, 0xffff
    s_mov_b32 s14, 1835008
    s_mov_b32 s15, 0x20000
    s_mov_b32 s16, s48
    s_and_b32 s17, s49, 0xffff
    s_mov_b32 s18, 1835008
    s_mov_b32 s19, 0x20000
    s_waitcnt lgkmcnt(0)
    s_barrier
    s_lshr_b32 s42, s2, 4
    s_mul_i32 s42, s42, 8448
    s_and_b32 s29, s2, 15
    s_lshl_b32 s29, s29, 2
    s_add_u32 s29, s29, s25
    s_lshl_b32 s29, s29, 7
    s_add_u32 s42, s42, s29
    s_add_u32 s42, s42, 23461888
    s_mov_b32 s28, 4096
    v_add_u32 v2, 0, v0
    v_mul_u32_u24 v3, 4682, v2
    v_lshrrev_b32 v3, 16, v3
    v_mul_u32_u24 v3, 3360, v3
    v_add3_u32 v160, v1, v3, 0
    v_add_u32 v2, 64, v0
    v_mul_u32_u24 v3, 4682, v2
    v_lshrrev_b32 v3, 16, v3
    v_mul_u32_u24 v3, 3360, v3
    v_add3_u32 v161, v1, v3, 0
    v_add_u32 v2, 128, v0
    v_mul_u32_u24 v3, 4682, v2
    v_lshrrev_b32 v3, 16, v3
    v_mul_u32_u24 v3, 3360, v3
    v_add3_u32 v162, v1, v3, 0
    v_add_u32 v2, 192, v0
    v_mul_u32_u24 v3, 4682, v2
    v_lshrrev_b32 v3, 16, v3
    v_mul_u32_u24 v3, 3360, v3
    v_add3_u32 v163, v1, v3, 0
    v_add_u32 v2, 256, v0
    v_mul_u32_u24 v3, 4682, v2
    v_lshrrev_b32 v3, 16, v3
    v_mul_u32_u24 v3, 3360, v3
    v_add3_u32 v164, v1, v3, s28
    v_add_u32 v2, 320, v0
    v_mul_u32_u24 v3, 4682, v2
    v_lshrrev_b32 v3, 16, v3
    v_mul_u32_u24 v3, 3360, v3
    v_add3_u32 v165, v1, v3, s28
    v_add_u32 v2, 384, v0
    v_mul_u32_u24 v3, 4682, v2
    v_lshrrev_b32 v3, 16, v3
    v_mul_u32_u24 v3, 3360, v3
    v_add3_u32 v166, v1, v3, s28
    s_waitcnt vmcnt(0)
    v_readfirstlane_b32 s70, v46
    v_mov_b32 v2, 157508
    s_mul_i32 s70, s70, 0x9e3779b1
    s_add_u32 s70, s70, 0x7f4a7c15
    v_mov_b32 v46, s70
    ds_write_b32 v2, v46 offset:8
    s_mov_b64 exec, 1
    buffer_store_dword v46, v13, s[20:23], s42 offen sc1
    s_mov_b64 exec, -1
    s_barrier
    s_lshr_b32 s28, s2, 3
    s_lshl_b32 s28, s28, 1
    s_add_u32 s28, s28, s31
    s_mul_i32 s28, s28, 14336
    s_and_b32 s29, s27, 3
    s_mul_i32 s29, s29, 896
    s_add_u32 s28, s28, s29
    buffer_load_dwordx4 v[4:7], v1, s[12:15], s28 offen
    s_add_u32 s28, s28, 3584
    buffer_load_dwordx4 v[4:7], v1, s[12:15], s28 offen
    s_add_u32 s28, s28, 3584
    buffer_load_dwordx4 v[4:7], v1, s[12:15], s28 offen
    s_add_u32 s28, s28, 3584
    buffer_load_dwordx4 v[4:7], v1, s[12:15], s28 offen
    s_add_u32 s28, s28, 3584
    s_mul_i32 s63, s31, 114688
    s_mul_i32 s33, s26, 224
    s_add_u32 s63, s63, s33
    s_mul_i32 s33, s31, 7168
    s_lshr_b32 s34, s25, 1
    s_mul_i32 s34, s34, 14464
    s_add_u32 s33, s33, s34
    s_add_u32 s33, s33, 65536
    s_lshl_b32 s64, s30, 15
    s_add_u32 s64, s64, 6291456
    s_mov_b32 s32, s63
    s_mov_b32 s35, s64
    s_mov_b32 s36, s33
    v_mov_b32 v48, 0
    v_mov_b32 v49, 0
    v_mov_b32 v50, 0
    v_mov_b32 v51, 0
    v_mov_b32 v52, 0
    v_mov_b32 v53, 0
    v_mov_b32 v54, 0
    v_mov_b32 v55, 0
    v_mov_b32 v56, 0
    v_mov_b32 v57, 0
    v_mov_b32 v58, 0
    v_mov_b32 v59, 0
    v_mov_b32 v60, 0
    v_mov_b32 v61, 0
    v_mov_b32 v62, 0
    v_mov_b32 v63, 0
    v_mov_b32 v64, 0
    v_mov_b32 v65, 0
    v_mov_b32 v66, 0
    v_mov_b32 v67, 0
    v_mov_b32 v68, 0
    v_mov_b32 v69, 0
    v_mov_b32 v70, 0
    v_mov_b32 v71, 0
    v_mov_b32 v72, 0
    v_mov_b32 v73, 0
    v_mov_b32 v74, 0
    v_mov_b32 v75, 0
    v_mov_b32 v76, 0
    v_mov_b32 v77, 0
    v_mov_b32 v78, 0
    v_mov_b32 v79, 0
    v_mov_b32 v80, 0
    v_mov_b32 v81, 0
    v_mov_b32 v82, 0
    v_mov_b32 v83, 0
    v_mov_b32 v84, 0
    v_mov_b32 v85, 0
    v_mov_b32 v86, 0
    v_mov_b32 v87, 0
    s_barrier
    s_mov_b32 m0, s36
    s_nop 0
    buffer_load_dwordx4 v160, s[12:15], s32 offen offset:0 lds
    buffer_load_dwordx4 v161, s[12:15], s32 offen offset:1024 lds
    buffer_load_dwordx4 v162, s[12:15], s32 offen offset:2048 lds
    buffer_load_dwordx4 v163, s[12:15], s32 offen offset:3072 lds
    s_add_u32 m0, s36, 4096
    s_nop 0
    buffer_load_dwordx4 v164, s[12:15], s32 offen offset:0 lds
    buffer_load_dwordx4 v165, s[12:15], s32 offen offset:1024 lds
    buffer_load_dwordx4 v166, s[12:15], s32 offen offset:2048 lds
    s_add_u32 s32, s63, 229376
    s_add_u32 s36, s33, 28928
    s_mul_i32 s45, s52, 8448
    s_add_u32 s45, s45, 23461888
    s_lshl_b32 s28, s25, 11
    s_add_u32 s45, s45, s28
    v_and_b32 v3, 15, v0
    v_lshlrev_b32 v3, 7, v3
    v_mov_b32 v88, 0
    v_mov_b32 v89, 0
    v_mov_b32 v90, 0
    v_mov_b32 v91, 0
    v_mov_b32 v92, 0
    v_mov_b32 v93, 0
    v_mov_b32 v94, 0
    v_mov_b32 v95, 0
    v_mov_b32 v96, 0
    v_mov_b32 v97, 0
    v_mov_b32 v98, 0
    v_mov_b32 v99, 0
    v_mov_b32 v100, 0
    v_mov_b32 v101, 0
    v_mov_b32 v102, 0
    v_mov_b32 v103, 0
    v_mov_b32 v104, 0
    v_mov_b32 v105, 0
    v_mov_b32 v106, 0
    v_mov_b32 v107, 0
    v_mov_b32 v108, 0
    v_mov_b32 v109, 0
    v_mov_b32 v110, 0
    v_mov_b32 v111, 0
    v_mov_b32 v112, 0
    v_mov_b32 v113, 0
    v_mov_b32 v114, 0
    v_mov_b32 v115, 0
    v_mov_b32 v116, 0
    v_mov_b32 v117, 0
    v_mov_b32 v118, 0
    v_mov_b32 v119, 0
    v_mov_b32 v120, 0
    v_mov_b32 v121, 0
    v_mov_b32 v122, 0
    v_mov_b32 v123, 0
    v_mov_b32 v124, 0
    v_mov_b32 v125, 0
    v_mov_b32 v126, 0
    v_mov_b32 v127, 0
    s_barrier
    s_mov_b64 exec, 0xffff
    buffer_load_dword v24, v3, s[20:23], s45 offen sc1
    s_mov_b64 exec, -1
    s_mov_b32 m0, s36
    s_nop 0
    buffer_load_dwordx4 v160, s[12:15], s32 offen offset:0 lds
    buffer_load_dwordx4 v161, s[12:15], s32 offen offset:1024 lds
    buffer_load_dwordx4 v162, s[12:15], s32 offen offset:2048 lds
    buffer_load_dwordx4 v163, s[12:15], s32 offen offset:3072 lds
    s_add_u32 m0, s36, 4096
    s_nop 0
    buffer_load_dwordx4 v164, s[12:15], s32 offen offset:0 lds
    buffer_load_dwordx4 v165, s[12:15], s32 offen offset:1024 lds
    buffer_load_dwordx4 v166, s[12:15], s32 offen offset:2048 lds
    s_waitcnt lgkmcnt(0)
    s_barrier
    s_setprio 0
    v_mov_b32 v128, 0
    v_mov_b32 v129, 0
    v_mov_b32 v130, 0
    v_mov_b32 v131, 0
    v_mov_b32 v132, 0
    v_mov_b32 v133, 0
    v_mov_b32 v134, 0
    v_mov_b32 v135, 0
    v_mov_b32 v136, 0
    v_mov_b32 v137, 0
    v_mov_b32 v138, 0
    v_mov_b32 v139, 0
    v_mov_b32 v140, 0
    v_mov_b32 v141, 0
    v_mov_b32 v142, 0
    v_mov_b32 v143, 0
    v_mov_b32 v144, 0
    v_mov_b32 v145, 0
    v_mov_b32 v146, 0
    v_mov_b32 v147, 0
    v_mov_b32 v148, 0
    v_mov_b32 v149, 0
    v_mov_b32 v150, 0
    v_mov_b32 v151, 0
    v_mov_b32 v152, 0
    v_mov_b32 v153, 0
    v_mov_b32 v154, 0
    v_mov_b32 v155, 0
    v_mov_b32 v156, 0
    v_mov_b32 v157, 0
    v_mov_b32 v158, 0
    v_mov_b32 v159, 0
    s_lshr_b32 s61, s2, 5
    s_lshl_b32 s61, s61, 2
    s_add_u32 s61, s61, s25
    s_mul_i32 s61, s61, 57344
    s_and_b32 s28, s26, 7
    s_lshl_b32 s28, s28, 7
    s_add_u32 s61, s61, s28
    v_mov_b32 v13, 1
    s_waitcnt vmcnt(7)
    ds_write_b32 v11, v13
    v_cmp_eq_u32 vcc, s70, v24
    s_nop 0
    s_and_b32 s43, vcc_lo, 0xffff
    s_cmp_eq_u32 s43, 0xffff
    s_cbranch_scc1 UX_GO
    s_mov_b32 s28, 0
    s_mov_b64 exec, 0xffff
UX_POLL:
    buffer_load_dword v4, v3, s[20:23], s45 offen sc1
    s_waitcnt vmcnt(0)
    v_cmp_ne_u32 vcc, s70, v4
    s_nop 0
    s_cmp_eq_u64 vcc, 0
    s_cbranch_scc1 UX_OUT
    s_mov_b64 exec, vcc
    s_sleep 4
    s_add_u32 s28, s28, 1
    s_cmp_lt_u32 s28, 0x100000
    s_cbranch_scc1 UX_POLL
UX_OUT:
    s_mov_b64 exec, -1
UX_GO:
    buffer_load_dwordx4 v[32:35], v1, s[20:23], s35 offen offset:0 sc1
    buffer_load_dwordx4 v[36:39], v1, s[20:23], s35 offen offset:1024 sc1
    buffer_load_dwordx4 v[40:43], v1, s[20:23], s35 offen offset:2048 sc1
    buffer_load_dwordx4 v[44:47], v1, s[20:23], s35 offen offset:3072 sc1
    buffer_load_dwordx4 v[4:7], v15, s[16:19], s60 offen
    v_lshrrev_b32 v8, 5, v0
    v_lshlrev_b32 v8, 3, v8
    v_bfe_u32 v3, v0, 2, 2
    v_add_u32 v8, v8, v3
    v_mul_u32_u24 v8, 224, v8
    v_bfe_u32 v3, v0, 4, 1
    v_mul_u32_u24 v3, 14464, v3
    v_add_u32 v8, v8, v3
    v_and_b32 v3, 3, v0
    v_lshl_add_u32 v8, v3, 3, v8
    v_add_u32 v8, 65536, v8
    v_and_b32 v12, 3, v0
    v_lshlrev_b32 v12, 8, v12
    v_lshl_add_u32 v12, v0, 2, v12
    v_add_u32 v12, 156416, v12
    ds_read_b32 v14, v12
    v_mov_b32 v9, v8
    v_add_u32 v10, 28928, v8
    s_mov_b32 s37, 57856
    s_mov_b32 s39, 1
    s_add_u32 s35, s64, 4096
    s_mov_b32 s62, 2
    s_add_u32 s32, s63, 458752
    s_sub_u32 s61, s61, 8192
    s_waitcnt lgkmcnt(0)
    v_cmp_le_u32 vcc, s39, v14
    s_nop 0
    s_cmp_eq_u64 vcc, -1
    s_cbranch_scc0 UB_SPIN
UB_CONT:
    s_mov_b32 exec_lo, 0
    v_and_b32 v12, 3, v0
    v_lshlrev_b32 v12, 2, v12
    v_add_u32 v12, 157536, v12
    s_mov_b32 exec_lo, -1
    v_mov_b32 v13, 2
    s_waitcnt vmcnt(1)
    ds_read_b64_tr_b16 v[16:17], v9 offset:0
    ds_read_b64_tr_b16 v[18:19], v9 offset:896
    ds_read_b64_tr_b16 v[20:21], v9 offset:32
    ds_read_b64_tr_b16 v[22:23], v9 offset:928
    ds_read_b64_tr_b16 v[24:25], v9 offset:64
    ds_read_b64_tr_b16 v[26:27], v9 offset:960
    ds_read_b64_tr_b16 v[28:29], v9 offset:96
    ds_read_b64_tr_b16 v[30:31], v9 offset:992
UP_LOOP:
    s_waitcnt vmcnt(11)
    s_waitcnt lgkmcnt(6)
    v_mfma_f32_32x32x16_bf16 v[48:63], v[16:19], v[32:35], v[48:63]
    ds_read_b64_tr_b16 v[16:17], v9 offset:128
    ds_read_b64_tr_b16 v[18:19], v9 offset:1024
    s_waitcnt lgkmcnt(6)
    v_mfma_f32_32x32x16_bf16 v[64:79], v[20:23], v[32:35], v[64:79]
    ds_read_b64_tr_b16 v[20:21], v9 offset:160
    ds_read_b64_tr_b16 v[22:23], v9 offset:1056
    s_waitcnt lgkmcnt(6)
    v_mfma_f32_32x32x16_bf16 v[80:95], v[24:27], v[32:35], v[80:95]
    ds_read_b64_tr_b16 v[24:25], v9 offset:192
    ds_read_b64_tr_b16 v[26:27], v9 offset:1088
    s_waitcnt lgkmcnt(6)
    v_mfma_f32_32x32x16_bf16 v[96:111], v[28:31], v[32:35], v[96:111]
    ds_read_b64_tr_b16 v[28:29], v9 offset:3584
    ds_read_b64_tr_b16 v[30:31], v9 offset:4480
    s_waitcnt lgkmcnt(6)
    v_mfma_f32_32x32x16_bf16 v[112:127], v[16:19], v[32:35], v[112:127]
    ds_read_b64_tr_b16 v[16:17], v9 offset:3616
    ds_read_b64_tr_b16 v[18:19], v9 offset:4512
    s_waitcnt lgkmcnt(6)
    v_mfma_f32_32x32x16_bf16 v[128:143], v[20:23], v[32:35], v[128:143]
    ds_read_b64_tr_b16 v[20:21], v9 offset:3648
    ds_read_b64_tr_b16 v[22:23], v9 offset:4544
    s_waitcnt lgkmcnt(6)
    v_mfma_f32_32x32x16_bf16 v[144:159], v[24:27], v[32:35], v[144:159]
    ds_read_b64_tr_b16 v[24:25], v9 offset:3680
    ds_read_b64_tr_b16 v[26:27], v9 offset:4576
    buffer_load_dwordx4 v[32:35], v1, s[20:23], s35 offen offset:0 sc1
    s_waitcnt vmcnt(11)
    s_waitcnt lgkmcnt(6)
    v_mfma_f32_32x32x16_bf16 v[48:63], v[28:31], v[36:39], v[48:63]
    ds_read_b64_tr_b16 v[28:29], v9 offset:3712
    ds_read_b64_tr_b16 v[30:31], v9 offset:4608
    s_waitcnt lgkmcnt(6)
    v_mfma_f32_32x32x16_bf16 v[64:79], v[16:19], v[36:39], v[64:79]
    ds_read_b64_tr_b16 v[16:17], v9 offset:3744
    ds_read_b64_tr_b16 v[18:19], v9 offset:4640
    s_waitcnt lgkmcnt(6)
    v_mfma_f32_32x32x16_bf16 v[80:95], v[20:23], v[36:39], v[80:95]
    ds_read_b64_tr_b16 v[20:21], v9 offset:3776
    ds_read_b64_tr_b16 v[22:23], v9 offset:4672
    s_waitcnt lgkmcnt(6)
    v_mfma_f32_32x32x16_bf16 v[96:111], v[24:27], v[36:39], v[96:111]
    ds_read_b64_tr_b16 v[24:25], v9 offset:7168
    ds_read_b64_tr_b16 v[26:27], v9 offset:8064
    s_waitcnt lgkmcnt(6)
    v_mfma_f32_32x32x16_bf16 v[112:127], v[28:31], v[36:39], v[112:127]
    ds_read_b64_tr_b16 v[28:29], v9 offset:7200
    ds_read_b64_tr_b16 v[30:31], v9 offset:8096
    s_waitcnt lgkmcnt(6)
    v_mfma_f32_32x32x16_bf16 v[128:143], v[16:19], v[36:39], v[128:143]
    ds_read_b64_tr_b16 v[16:17], v9 offset:7232
    ds_read_b64_tr_b16 v[18:19], v9 offset:8128
    s_waitcnt lgkmcnt(6)
    v_mfma_f32_32x32x16_bf16 v[144:159], v[20:23], v[36:39], v[144:159]
    ds_read_b64_tr_b16 v[20:21], v9 offset:7264
    ds_read_b64_tr_b16 v[22:23], v9 offset:8160
    buffer_load_dwordx4 v[36:39], v1, s[20:23], s35 offen offset:1024 sc1
    s_waitcnt vmcnt(11)
    s_waitcnt lgkmcnt(6)
    v_mfma_f32_32x32x16_bf16 v[48:63], v[24:27], v[40:43], v[48:63]
    ds_read_b64_tr_b16 v[24:25], v9 offset:7296
    ds_read_b64_tr_b16 v[26:27], v9 offset:8192
    s_waitcnt lgkmcnt(6)
    v_mfma_f32_32x32x16_bf16 v[64:79], v[28:31], v[40:43], v[64:79]
    ds_read_b64_tr_b16 v[28:29], v9 offset:7328
    ds_read_b64_tr_b16 v[30:31], v9 offset:8224
    s_waitcnt lgkmcnt(6)
    v_mfma_f32_32x32x16_bf16 v[80:95], v[16:19], v[40:43], v[80:95]
    ds_read_b64_tr_b16 v[16:17], v9 offset:7360
    ds_read_b64_tr_b16 v[18:19], v9 offset:8256
    s_waitcnt vmcnt(4)
    ds_write_b32 v11, v13
    s_waitcnt lgkmcnt(7)
    v_mfma_f32_32x32x16_bf16 v[96:111], v[20:23], v[40:43], v[96:111]
    ds_read_b64_tr_b16 v[20:21], v9 offset:10752
    ds_read_b64_tr_b16 v[22:23], v9 offset:11648
    s_waitcnt lgkmcnt(7)
    v_mfma_f32_32x32x16_bf16 v[112:127], v[24:27], v[40:43], v[112:127]
    ds_read_b64_tr_b16 v[24:25], v9 offset:10784
    ds_read_b64_tr_b16 v[26:27], v9 offset:11680
    s_waitcnt lgkmcnt(7)
    v_mfma_f32_32x32x16_bf16 v[128:143], v[28:31], v[40:43], v[128:143]
    ds_read_b64_tr_b16 v[28:29], v9 offset:10816
    ds_read_b64_tr_b16 v[30:31], v9 offset:11712
    s_waitcnt lgkmcnt(7)
    v_mfma_f32_32x32x16_bf16 v[144:159], v[16:19], v[40:43], v[144:159]
    ds_read_b64_tr_b16 v[16:17], v9 offset:10848
    ds_read_b64_tr_b16 v[18:19], v9 offset:11744
    buffer_load_dwordx4 v[40:43], v1, s[20:23], s35 offen offset:2048 sc1
    s_waitcnt vmcnt(4)
    s_waitcnt lgkmcnt(6)
    v_mfma_f32_32x32x16_bf16 v[48:63], v[20:23], v[44:47], v[48:63]
    ds_read_b64_tr_b16 v[20:21], v9 offset:10880
    ds_read_b64_tr_b16 v[22:23], v9 offset:11776
    ds_read_b32 v14, v12
    s_waitcnt lgkmcnt(7)
    v_mfma_f32_32x32x16_bf16 v[64:79], v[24:27], v[44:47], v[64:79]
    ds_read_b64_tr_b16 v[24:25], v9 offset:10912
    ds_read_b64_tr_b16 v[26:27], v9 offset:11808
    s_waitcnt lgkmcnt(7)
    v_mfma_f32_32x32x16_bf16 v[80:95], v[28:31], v[44:47], v[80:95]
    ds_read_b64_tr_b16 v[28:29], v9 offset:10944
    ds_read_b64_tr_b16 v[30:31], v9 offset:11840
    s_waitcnt lgkmcnt(4)
    s_add_u32 s39, s39, 1
    s_setprio 3
    v_cmp_le_u32 vcc, s39, v14
    s_nop 0
    s_cmp_eq_u64 vcc, -1
    s_cbranch_scc0 UP_SPIN
UP_CONT:
    v_add_u32 v13, 1, v13
    s_setprio 0
    s_add_u32 s36, s33, s37
    v_mfma_f32_32x32x16_bf16 v[96:111], v[16:19], v[44:47], v[96:111]
    ds_read_b64_tr_b16 v[16:17], v10 offset:0
    ds_read_b64_tr_b16 v[18:19], v10 offset:896
    s_mov_b32 m0, s36
    s_nop 0
    buffer_load_dwordx4 v160, s[12:15], s32 offen offset:0 lds
    buffer_load_dwordx4 v161, s[12:15], s32 offen offset:1024 lds
    s_waitcnt lgkmcnt(6)
    v_mfma_f32_32x32x16_bf16 v[112:127], v[20:23], v[44:47], v[112:127]
    ds_read_b64_tr_b16 v[20:21], v10 offset:32
    ds_read_b64_tr_b16 v[22:23], v10 offset:928
    buffer_load_dwordx4 v162, s[12:15], s32 offen offset:2048 lds
    buffer_load_dwordx4 v163, s[12:15], s32 offen offset:3072 lds
    s_waitcnt lgkmcnt(6)
    v_mfma_f32_32x32x16_bf16 v[128:143], v[24:27], v[44:47], v[128:143]
    ds_read_b64_tr_b16 v[24:25], v10 offset:64
    ds_read_b64_tr_b16 v[26:27], v10 offset:960
    s_add_u32 m0, s36, 4096
    s_nop 0
    buffer_load_dwordx4 v164, s[12:15], s32 offen offset:0 lds
    s_waitcnt lgkmcnt(6)
    v_mfma_f32_32x32x16_bf16 v[144:159], v[28:31], v[44:47], v[144:159]
    ds_read_b64_tr_b16 v[28:29], v10 offset:96
    ds_read_b64_tr_b16 v[30:31], v10 offset:992
    buffer_load_dwordx4 v165, s[12:15], s32 offen offset:1024 lds
    buffer_load_dwordx4 v166, s[12:15], s32 offen offset:2048 lds
    buffer_load_dwordx4 v[44:47], v1, s[20:23], s35 offen offset:3072 sc1
    s_cmp_ge_u32 s39, 5
    s_cselect_b32 s28, 8192, 0
    s_add_u32 s61, s61, s28
    s_cmp_ge_u32 s39, 5
    s_cselect_b32 s28, s61, s60
    buffer_load_dwordx4 v[4:7], v15, s[16:19], s28 offen
    s_setprio 3
    v_mov_b32 v9, v10
    v_add_u32 v10, s37, v8
    s_setprio 0
    s_lshl_b32 s35, s62, 12
    s_add_u32 s35, s35, s64
    s_add_u32 s62, s62, 1
    s_and_b32 s62, s62, 7
    s_mul_i32 s32, s62, 229376
    s_add_u32 s32, s32, s63
    s_cmp_lt_u32 s39, 7
    s_cselect_b32 s32, s32, s60
    s_cmp_lt_u32 s39, 8
    s_cselect_b32 s35, s35, s60
    s_add_u32 s37, s37, 28928
    s_cmp_eq_u32 s37, 86784
    s_cselect_b32 s37, 0, s37
    s_cmp_lt_u32 s39, 9
    s_cbranch_scc1 UP_LOOP
    s_setprio 3
    s_mul_i32 s40, s30, 112
    s_lshr_b32 s41, s26, 2
    s_mul_i32 s41, s41, 28
    s_add_u32 s40, s40, s41
    s_and_b32 s41, s26, 3
    s_add_u32 s40, s40, s41
    s_lshl_b32 s40, s40, 10
    s_add_u32 s40, s40, 9437184
    s_waitcnt vmcnt(0) lgkmcnt(0)
    ds_write_b32 v11, v13
    ds_read_b32 v14, v12
    s_lshl_b32 s53, s52, 1
    s_lshr_b32 s28, s26, 3
    s_add_u32 s53, s53, s28
    s_and_b32 s54, s26, 7
    s_lshr_b32 s63, s25, 1
    s_and_b32 s64, s25, 1
    s_mov_b32 s12, s48
    s_and_b32 s13, s49, 0xffff
    s_mov_b32 s14, 1835008
    s_mov_b32 s15, 0x20000
    s_mov_b32 s16, s50
    s_and_b32 s17, s51, 0xffff
    s_mov_b32 s18, 2097152
    s_mov_b32 s19, 0x20000
    v_lshrrev_b32 v2, 3, v0
    v_lshlrev_b32 v2, 10, v2
    v_bfe_u32 v3, v0, 2, 1
    v_bfe_u32 v4, v0, 4, 1
    v_xor_b32 v3, v3, v4
    v_lshl_add_u32 v2, v3, 6, v2
    v_and_b32 v3, 3, v0
    v_lshl_add_u32 v2, v3, 4, v2
    v_add_u32 v15, 7168, v2
    s_lshl_b32 s32, s25, 14
    s_add_u32 s32, s32, 65536
    v_lshrrev_b32 v8, 5, v0
    v_lshlrev_b32 v3, 2, v8
    v_bfe_u32 v4, v0, 2, 2
    v_add_u32 v3, v3, v4
    v_lshlrev_b32 v3, 7, v3
    v_bfe_u32 v4, v0, 3, 1
    v_xor_b32 v4, s64, v4
    v_lshl_add_u32 v3, v4, 6, v3
    v_bfe_u32 v4, v0, 4, 1
    v_lshl_add_u32 v3, v4, 5, v3
    v_and_b32 v4, 1, v0
    v_lshl_add_u32 v3, v4, 4, v3
    v_bfe_u32 v4, v0, 1, 1
    v_lshl_add_u32 v3, v4, 3, v3
    v_xor_b32 v4, 64, v3
    v_add_u32 v5, s32, v3
    v_add_u32 v6, s32, v4
    v_add_u32 v9, 8192, v5
    v_add_u32 v10, 8192, v6
    s_mul_i32 s33, s25, 458752
    s_lshl_b32 s55, s54, 7
    s_add_u32 s33, s33, s55
    s_mov_b32 s65, 114688
    s_mov_b32 s66, 4294639616
    s_mul_i32 s34, s53, 229376
    s_mul_i32 s35, s25, 28672
    s_add_u32 s34, s34, s35
    s_add_u32 s34, s34, 9437184
    s_mul_i32 s28, s63, 114688
    s_add_u32 s35, s34, 114688
    s_sub_u32 s35, s35, s28
    s_add_u32 s34, s34, s28
    s_lshr_b32 s38, s30, 1
    s_lshl_b32 s38, s38, 10
    s_lshr_b32 s28, s26, 2
    s_lshl_b32 s28, s28, 8
    s_add_u32 s38, s38, s28
    s_and_b32 s28, s26, 3
    s_lshl_b32 s28, s28, 3
    s_add_u32 s38, s38, s28
    s_and_b32 s28, s30, 1
    s_lshl_b32 s28, s28, 2
    s_add_u32 s38, s38, s28
    s_add_u32 s38, s38, 23068672
    s_lshl_b32 s45, s53, 10
    s_lshl_b32 s28, s25, 8
    s_add_u32 s45, s45, s28
    s_add_u32 s45, s45, 23068672
    v_and_b32 v3, 7, v0
    v_lshlrev_b32 v3, 2, v3
    v_mov_b32 v7, 0
    v_mov_b32 v167, s70
    s_waitcnt lgkmcnt(0)
    s_mov_b32 s39, 10
    v_cmp_le_u32 vcc, s39, v14
    s_nop 0
    s_cmp_eq_u64 vcc, -1
    s_cbranch_scc0 U9_SPIN
U9_CONT:
    s_mov_b32 s36, s32
    v_mul_f32 v16, 0xbfb8aa3b, v48
    v_mul_f32 v17, 0xbfb8aa3b, v49
    v_mul_f32 v18, 0xbfb8aa3b, v50
    v_mul_f32 v19, 0xbfb8aa3b, v51
    v_mul_f32 v20, 0xbfb8aa3b, v52
    v_mul_f32 v21, 0xbfb8aa3b, v53
    v_mul_f32 v22, 0xbfb8aa3b, v54
    v_mul_f32 v23, 0xbfb8aa3b, v55
    v_exp_f32 v16, v16
    v_exp_f32 v17, v17
    v_exp_f32 v18, v18
    v_exp_f32 v19, v19
    v_exp_f32 v20, v20
    v_exp_f32 v21, v21
    v_exp_f32 v22, v22
    v_exp_f32 v23, v23
    v_mul_f32 v48, v48, v56
    v_mul_f32 v49, v49, v57
    v_mul_f32 v50, v50, v58
    v_mul_f32 v51, v51, v59
    v_mul_f32 v52, v52, v60
    v_mul_f32 v53, v53, v61
    v_mul_f32 v54, v54, v62
    v_mul_f32 v55, v55, v63
    v_add_f32 v16, 1.0, v16
    v_add_f32 v17, 1.0, v17
    v_add_f32 v18, 1.0, v18
    v_add_f32 v19, 1.0, v19
    v_add_f32 v20, 1.0, v20
    v_add_f32 v21, 1.0, v21
    v_add_f32 v22, 1.0, v22
    v_add_f32 v23, 1.0, v23
    v_rcp_f32 v16, v16
    v_rcp_f32 v17, v17
    v_rcp_f32 v18, v18
    v_rcp_f32 v19, v19
    v_rcp_f32 v20, v20
    v_rcp_f32 v21, v21
    v_rcp_f32 v22, v22
    v_rcp_f32 v23, v23
    v_mul_f32 v48, v48, v16
    v_mul_f32 v49, v49, v17
    v_mul_f32 v50, v50, v18
    v_mul_f32 v51, v51, v19
    v_mul_f32 v52, v52, v20
    v_mul_f32 v53, v53, v21
    v_mul_f32 v54, v54, v22
    v_mul_f32 v55, v55, v23
    v_cvt_pk_bf16_f32 v24, v48, v49
    v_cvt_pk_bf16_f32 v25, v50, v51
    v_cvt_pk_bf16_f32 v26, v52, v53
    v_cvt_pk_bf16_f32 v27, v54, v55
    buffer_store_dwordx4 v[24:27], v1, s[20:23], s40 offen sc1
    s_add_u32 s40, s40, 4096
    s_add_u32 m0, s36, 0
    s_nop 0
    buffer_load_dwordx4 v2, s[12:15], s33 offen lds
    buffer_load_dwordx4 v15, s[12:15], s33 offen offset:1024 lds
    s_add_u32 s33, s33, s65
    v_mul_f32 v28, 0xbfb8aa3b, v64
    v_mul_f32 v29, 0xbfb8aa3b, v65
    v_mul_f32 v30, 0xbfb8aa3b, v66
    v_mul_f32 v31, 0xbfb8aa3b, v67
    v_mul_f32 v32, 0xbfb8aa3b, v68
    v_mul_f32 v33, 0xbfb8aa3b, v69
    v_mul_f32 v34, 0xbfb8aa3b, v70
    v_mul_f32 v35, 0xbfb8aa3b, v71
    v_exp_f32 v28, v28
    v_exp_f32 v29, v29
    v_exp_f32 v30, v30
    v_exp_f32 v31, v31
    v_exp_f32 v32, v32
    v_exp_f32 v33, v33
    v_exp_f32 v34, v34
    v_exp_f32 v35, v35
    v_mul_f32 v64, v64, v72
    v_mul_f32 v65, v65, v73
    v_mul_f32 v66, v66, v74
    v_mul_f32 v67, v67, v75
    v_mul_f32 v68, v68, v76
    v_mul_f32 v69, v69, v77
    v_mul_f32 v70, v70, v78
    v_mul_f32 v71, v71, v79
    v_add_f32 v28, 1.0, v28
    v_add_f32 v29, 1.0, v29
    v_add_f32 v30, 1.0, v30
    v_add_f32 v31, 1.0, v31
    v_add_f32 v32, 1.0, v32
    v_add_f32 v33, 1.0, v33
    v_add_f32 v34, 1.0, v34
    v_add_f32 v35, 1.0, v35
    v_rcp_f32 v28, v28
    v_rcp_f32 v29, v29
    v_rcp_f32 v30, v30
    v_rcp_f32 v31, v31
    v_rcp_f32 v32, v32
    v_rcp_f32 v33, v33
    v_rcp_f32 v34, v34
    v_rcp_f32 v35, v35
    v_mul_f32 v64, v64, v28
    v_mul_f32 v65, v65, v29
    v_mul_f32 v66, v66, v30
    v_mul_f32 v67, v67, v31
    v_mul_f32 v68, v68, v32
    v_mul_f32 v69, v69, v33
    v_mul_f32 v70, v70, v34
    v_mul_f32 v71, v71, v35
    v_cvt_pk_bf16_f32 v36, v64, v65
    v_cvt_pk_bf16_f32 v37, v66, v67
    v_cvt_pk_bf16_f32 v38, v68, v69
    v_cvt_pk_bf16_f32 v39, v70, v71
    buffer_store_dwordx4 v[36:39], v1, s[20:23], s40 offen sc1
    s_add_u32 s40, s40, 4096
    s_add_u32 m0, s36, 2048
    s_nop 0
    buffer_load_dwordx4 v2, s[12:15], s33 offen lds
    buffer_load_dwordx4 v15, s[12:15], s33 offen offset:1024 lds
    s_add_u32 s33, s33, s65
    v_mul_f32 v16, 0xbfb8aa3b, v80
    v_mul_f32 v17, 0xbfb8aa3b, v81
    v_mul_f32 v18, 0xbfb8aa3b, v82
    v_mul_f32 v19, 0xbfb8aa3b, v83
    v_mul_f32 v20, 0xbfb8aa3b, v84
    v_mul_f32 v21, 0xbfb8aa3b, v85
    v_mul_f32 v22, 0xbfb8aa3b, v86
    v_mul_f32 v23, 0xbfb8aa3b, v87
    v_exp_f32 v16, v16
    v_exp_f32 v17, v17
    v_exp_f32 v18, v18
    v_exp_f32 v19, v19
    v_exp_f32 v20, v20
    v_exp_f32 v21, v21
    v_exp_f32 v22, v22
    v_exp_f32 v23, v23
    v_mul_f32 v80, v80, v88
    v_mul_f32 v81, v81, v89
    v_mul_f32 v82, v82, v90
    v_mul_f32 v83, v83, v91
    v_mul_f32 v84, v84, v92
    v_mul_f32 v85, v85, v93
    v_mul_f32 v86, v86, v94
    v_mul_f32 v87, v87, v95
    v_add_f32 v16, 1.0, v16
    v_add_f32 v17, 1.0, v17
    v_add_f32 v18, 1.0, v18
    v_add_f32 v19, 1.0, v19
    v_add_f32 v20, 1.0, v20
    v_add_f32 v21, 1.0, v21
    v_add_f32 v22, 1.0, v22
    v_add_f32 v23, 1.0, v23
    v_rcp_f32 v16, v16
    v_rcp_f32 v17, v17
    v_rcp_f32 v18, v18
    v_rcp_f32 v19, v19
    v_rcp_f32 v20, v20
    v_rcp_f32 v21, v21
    v_rcp_f32 v22, v22
    v_rcp_f32 v23, v23
    v_mul_f32 v80, v80, v16
    v_mul_f32 v81, v81, v17
    v_mul_f32 v82, v82, v18
    v_mul_f32 v83, v83, v19
    v_mul_f32 v84, v84, v20
    v_mul_f32 v85, v85, v21
    v_mul_f32 v86, v86, v22
    v_mul_f32 v87, v87, v23
    v_cvt_pk_bf16_f32 v24, v80, v81
    v_cvt_pk_bf16_f32 v25, v82, v83
    v_cvt_pk_bf16_f32 v26, v84, v85
    v_cvt_pk_bf16_f32 v27, v86, v87
    buffer_store_dwordx4 v[24:27], v1, s[20:23], s40 offen sc1
    s_add_u32 s40, s40, 4096
    s_add_u32 m0, s36, 4096
    s_nop 0
    buffer_load_dwordx4 v2, s[12:15], s33 offen lds
    buffer_load_dwordx4 v15, s[12:15], s33 offen offset:1024 lds
    s_add_u32 s33, s33, s65
    v_mul_f32 v28, 0xbfb8aa3b, v96
    v_mul_f32 v29, 0xbfb8aa3b, v97
    v_mul_f32 v30, 0xbfb8aa3b, v98
    v_mul_f32 v31, 0xbfb8aa3b, v99
    v_mul_f32 v32, 0xbfb8aa3b, v100
    v_mul_f32 v33, 0xbfb8aa3b, v101
    v_mul_f32 v34, 0xbfb8aa3b, v102
    v_mul_f32 v35, 0xbfb8aa3b, v103
    v_exp_f32 v28, v28
    v_exp_f32 v29, v29
    v_exp_f32 v30, v30
    v_exp_f32 v31, v31
    v_exp_f32 v32, v32
    v_exp_f32 v33, v33
    v_exp_f32 v34, v34
    v_exp_f32 v35, v35
    v_mul_f32 v96, v96, v104
    v_mul_f32 v97, v97, v105
    v_mul_f32 v98, v98, v106
    v_mul_f32 v99, v99, v107
    v_mul_f32 v100, v100, v108
    v_mul_f32 v101, v101, v109
    v_mul_f32 v102, v102, v110
    v_mul_f32 v103, v103, v111
    v_add_f32 v28, 1.0, v28
    v_add_f32 v29, 1.0, v29
    v_add_f32 v30, 1.0, v30
    v_add_f32 v31, 1.0, v31
    v_add_f32 v32, 1.0, v32
    v_add_f32 v33, 1.0, v33
    v_add_f32 v34, 1.0, v34
    v_add_f32 v35, 1.0, v35
    v_rcp_f32 v28, v28
    v_rcp_f32 v29, v29
    v_rcp_f32 v30, v30
    v_rcp_f32 v31, v31
    v_rcp_f32 v32, v32
    v_rcp_f32 v33, v33
    v_rcp_f32 v34, v34
    v_rcp_f32 v35, v35
    v_mul_f32 v96, v96, v28
    v_mul_f32 v97, v97, v29
    v_mul_f32 v98, v98, v30
    v_mul_f32 v99, v99, v31
    v_mul_f32 v100, v100, v32
    v_mul_f32 v101, v101, v33
    v_mul_f32 v102, v102, v34
    v_mul_f32 v103, v103, v35
    v_cvt_pk_bf16_f32 v36, v96, v97
    v_cvt_pk_bf16_f32 v37, v98, v99
    v_cvt_pk_bf16_f32 v38, v100, v101
    v_cvt_pk_bf16_f32 v39, v102, v103
    buffer_store_dwordx4 v[36:39], v1, s[20:23], s40 offen sc1
    s_add_u32 s40, s40, 4096
    s_add_u32 m0, s36, 6144
    s_nop 0
    buffer_load_dwordx4 v2, s[12:15], s33 offen lds
    buffer_load_dwordx4 v15, s[12:15], s33 offen offset:1024 lds
    s_add_u32 s33, s33, s66
    v_mul_f32 v16, 0xbfb8aa3b, v112
    v_mul_f32 v17, 0xbfb8aa3b, v113
    v_mul_f32 v18, 0xbfb8aa3b, v114
    v_mul_f32 v19, 0xbfb8aa3b, v115
    v_mul_f32 v20, 0xbfb8aa3b, v116
    v_mul_f32 v21, 0xbfb8aa3b, v117
    v_mul_f32 v22, 0xbfb8aa3b, v118
    v_mul_f32 v23, 0xbfb8aa3b, v119
    v_exp_f32 v16, v16
    v_exp_f32 v17, v17
    v_exp_f32 v18, v18
    v_exp_f32 v19, v19
    v_exp_f32 v20, v20
    v_exp_f32 v21, v21
    v_exp_f32 v22, v22
    v_exp_f32 v23, v23
    v_mul_f32 v112, v112, v120
    v_mul_f32 v113, v113, v121
    v_mul_f32 v114, v114, v122
    v_mul_f32 v115, v115, v123
    v_mul_f32 v116, v116, v124
    v_mul_f32 v117, v117, v125
    v_mul_f32 v118, v118, v126
    v_mul_f32 v119, v119, v127
    v_add_f32 v16, 1.0, v16
    v_add_f32 v17, 1.0, v17
    v_add_f32 v18, 1.0, v18
    v_add_f32 v19, 1.0, v19
    v_add_f32 v20, 1.0, v20
    v_add_f32 v21, 1.0, v21
    v_add_f32 v22, 1.0, v22
    v_add_f32 v23, 1.0, v23
    v_rcp_f32 v16, v16
    v_rcp_f32 v17, v17
    v_rcp_f32 v18, v18
    v_rcp_f32 v19, v19
    v_rcp_f32 v20, v20
    v_rcp_f32 v21, v21
    v_rcp_f32 v22, v22
    v_rcp_f32 v23, v23
    v_mul_f32 v112, v112, v16
    v_mul_f32 v113, v113, v17
    v_mul_f32 v114, v114, v18
    v_mul_f32 v115, v115, v19
    v_mul_f32 v116, v116, v20
    v_mul_f32 v117, v117, v21
    v_mul_f32 v118, v118, v22
    v_mul_f32 v119, v119, v23
    v_cvt_pk_bf16_f32 v24, v112, v113
    v_cvt_pk_bf16_f32 v25, v114, v115
    v_cvt_pk_bf16_f32 v26, v116, v117
    v_cvt_pk_bf16_f32 v27, v118, v119
    buffer_store_dwordx4 v[24:27], v1, s[20:23], s40 offen sc1
    s_add_u32 s40, s40, 4096
    s_add_u32 m0, s36, 8192
    s_nop 0
    buffer_load_dwordx4 v2, s[12:15], s33 offen lds
    buffer_load_dwordx4 v15, s[12:15], s33 offen offset:1024 lds
    s_add_u32 s33, s33, s65
    v_mul_f32 v28, 0xbfb8aa3b, v128
    v_mul_f32 v29, 0xbfb8aa3b, v129
    v_mul_f32 v30, 0xbfb8aa3b, v130
    v_mul_f32 v31, 0xbfb8aa3b, v131
    v_mul_f32 v32, 0xbfb8aa3b, v132
    v_mul_f32 v33, 0xbfb8aa3b, v133
    v_mul_f32 v34, 0xbfb8aa3b, v134
    v_mul_f32 v35, 0xbfb8aa3b, v135
    v_exp_f32 v28, v28
    v_exp_f32 v29, v29
    v_exp_f32 v30, v30
    v_exp_f32 v31, v31
    v_exp_f32 v32, v32
    v_exp_f32 v33, v33
    v_exp_f32 v34, v34
    v_exp_f32 v35, v35
    v_mul_f32 v128, v128, v136
    v_mul_f32 v129, v129, v137
    v_mul_f32 v130, v130, v138
    v_mul_f32 v131, v131, v139
    v_mul_f32 v132, v132, v140
    v_mul_f32 v133, v133, v141
    v_mul_f32 v134, v134, v142
    v_mul_f32 v135, v135, v143
    v_add_f32 v28, 1.0, v28
    v_add_f32 v29, 1.0, v29
    v_add_f32 v30, 1.0, v30
    v_add_f32 v31, 1.0, v31
    v_add_f32 v32, 1.0, v32
    v_add_f32 v33, 1.0, v33
    v_add_f32 v34, 1.0, v34
    v_add_f32 v35, 1.0, v35
    v_rcp_f32 v28, v28
    v_rcp_f32 v29, v29
    v_rcp_f32 v30, v30
    v_rcp_f32 v31, v31
    v_rcp_f32 v32, v32
    v_rcp_f32 v33, v33
    v_rcp_f32 v34, v34
    v_rcp_f32 v35, v35
    v_mul_f32 v128, v128, v28
    v_mul_f32 v129, v129, v29
    v_mul_f32 v130, v130, v30
    v_mul_f32 v131, v131, v31
    v_mul_f32 v132, v132, v32
    v_mul_f32 v133, v133, v33
    v_mul_f32 v134, v134, v34
    v_mul_f32 v135, v135, v35
    v_cvt_pk_bf16_f32 v36, v128, v129
    v_cvt_pk_bf16_f32 v37, v130, v131
    v_cvt_pk_bf16_f32 v38, v132, v133
    v_cvt_pk_bf16_f32 v39, v134, v135
    buffer_store_dwordx4 v[36:39], v1, s[20:23], s40 offen sc1
    s_add_u32 s40, s40, 4096
    s_add_u32 m0, s36, 10240
    s_nop 0
    buffer_load_dwordx4 v2, s[12:15], s33 offen lds
    buffer_load_dwordx4 v15, s[12:15], s33 offen offset:1024 lds
    s_add_u32 s33, s33, s65
    v_mul_f32 v16, 0xbfb8aa3b, v144
    v_mul_f32 v17, 0xbfb8aa3b, v145
    v_mul_f32 v18, 0xbfb8aa3b, v146
    v_mul_f32 v19, 0xbfb8aa3b, v147
    v_mul_f32 v20, 0xbfb8aa3b, v148
    v_mul_f32 v21, 0xbfb8aa3b, v149
    v_mul_f32 v22, 0xbfb8aa3b, v150
    v_mul_f32 v23, 0xbfb8aa3b, v151
    v_exp_f32 v16, v16
    v_exp_f32 v17, v17
    v_exp_f32 v18, v18
    v_exp_f32 v19, v19
    v_exp_f32 v20, v20
    v_exp_f32 v21, v21
    v_exp_f32 v22, v22
    v_exp_f32 v23, v23
    v_mul_f32 v144, v144, v152
    v_mul_f32 v145, v145, v153
    v_mul_f32 v146, v146, v154
    v_mul_f32 v147, v147, v155
    v_mul_f32 v148, v148, v156
    v_mul_f32 v149, v149, v157
    v_mul_f32 v150, v150, v158
    v_mul_f32 v151, v151, v159
    v_add_f32 v16, 1.0, v16
    v_add_f32 v17, 1.0, v17
    v_add_f32 v18, 1.0, v18
    v_add_f32 v19, 1.0, v19
    v_add_f32 v20, 1.0, v20
    v_add_f32 v21, 1.0, v21
    v_add_f32 v22, 1.0, v22
    v_add_f32 v23, 1.0, v23
    v_rcp_f32 v16, v16
    v_rcp_f32 v17, v17
    v_rcp_f32 v18, v18
    v_rcp_f32 v19, v19
    v_rcp_f32 v20, v20
    v_rcp_f32 v21, v21
    v_rcp_f32 v22, v22
    v_rcp_f32 v23, v23
    v_mul_f32 v144, v144, v16
    v_mul_f32 v145, v145, v17
    v_mul_f32 v146, v146, v18
    v_mul_f32 v147, v147, v19
    v_mul_f32 v148, v148, v20
    v_mul_f32 v149, v149, v21
    v_mul_f32 v150, v150, v22
    v_mul_f32 v151, v151, v23
    v_cvt_pk_bf16_f32 v24, v144, v145
    v_cvt_pk_bf16_f32 v25, v146, v147
    v_cvt_pk_bf16_f32 v26, v148, v149
    v_cvt_pk_bf16_f32 v27, v150, v151
    s_waitcnt vmcnt(8)
    s_mov_b64 exec, 1
    buffer_store_dword v167, v7, s[20:23], s38 offen offset:0 sc1
    s_mov_b64 exec, -1
    buffer_store_dwordx4 v[24:27], v1, s[20:23], s40 offen sc1
    s_add_u32 s40, s40, 4096
    s_add_u32 m0, s36, 12288
    s_nop 0
    buffer_load_dwordx4 v2, s[12:15], s33 offen lds
    buffer_load_dwordx4 v15, s[12:15], s33 offen offset:1024 lds
    s_add_u32 s33, s33, s65
    buffer_load_dword v4, v3, s[20:23], s45 offen sc1
    v_mov_b32 v48, 0
    v_mov_b32 v49, 0
    v_mov_b32 v50, 0
    v_mov_b32 v51, 0
    v_mov_b32 v52, 0
    v_mov_b32 v53, 0
    v_mov_b32 v54, 0
    v_mov_b32 v55, 0
    v_mov_b32 v56, 0
    v_mov_b32 v57, 0
    v_mov_b32 v58, 0
    v_mov_b32 v59, 0
    v_mov_b32 v60, 0
    v_mov_b32 v61, 0
    v_mov_b32 v62, 0
    v_mov_b32 v63, 0
    v_mov_b32 v64, 0
    v_mov_b32 v65, 0
    v_mov_b32 v66, 0
    v_mov_b32 v67, 0
    v_mov_b32 v68, 0
    v_mov_b32 v69, 0
    v_mov_b32 v70, 0
    v_mov_b32 v71, 0
    v_mov_b32 v72, 0
    v_mov_b32 v73, 0
    v_mov_b32 v74, 0
    v_mov_b32 v75, 0
    v_mov_b32 v76, 0
    v_mov_b32 v77, 0
    v_mov_b32 v78, 0
    v_mov_b32 v79, 0
    v_mov_b32 v80, 0
    v_mov_b32 v81, 0
    v_mov_b32 v82, 0
    v_mov_b32 v83, 0
    v_mov_b32 v84, 0
    v_mov_b32 v85, 0
    v_mov_b32 v86, 0
    v_mov_b32 v87, 0
    v_mov_b32 v88, 0
    v_mov_b32 v89, 0
    v_mov_b32 v90, 0
    v_mov_b32 v91, 0
    v_mov_b32 v92, 0
    v_mov_b32 v93, 0
    v_mov_b32 v94, 0
    v_mov_b32 v95, 0
    v_mov_b32 v96, 0
    v_mov_b32 v97, 0
    v_mov_b32 v98, 0
    v_mov_b32 v99, 0
    v_mov_b32 v100, 0
    v_mov_b32 v101, 0
    v_mov_b32 v102, 0
    v_mov_b32 v103, 0
    v_mov_b32 v104, 0
    v_mov_b32 v105, 0
    v_mov_b32 v106, 0
    v_mov_b32 v107, 0
    v_mov_b32 v108, 0
    v_mov_b32 v109, 0
    v_mov_b32 v110, 0
    v_mov_b32 v111, 0
    v_and_b32 v152, 31, v0
    v_lshlrev_b32 v152, 10, v152
    v_lshl_add_u32 v152, v8, 4, v152
    s_lshl_b32 s40, s53, 16
    s_lshl_b32 s41, s63, 15
    s_add_u32 s40, s40, s41
    s_add_u32 s40, s40, s55
    s_lshl_b32 s41, s64, 6
    s_add_u32 s40, s40, s41
    s_waitcnt vmcnt(3)
    s_mov_b64 exec, 1
    buffer_store_dword v167, v7, s[20:23], s38 offen offset:32 sc1
    s_mov_b64 exec, -1
    s_waitcnt vmcnt(1)
    v_cmp_eq_u32 vcc, s70, v4
    s_nop 0
    s_cmp_eq_u64 vcc, -1
    s_cbranch_scc1 DH_GO
    s_mov_b32 s28, 0
DH_POLL:
    buffer_load_dword v4, v3, s[20:23], s45 offen sc1
    s_waitcnt vmcnt(0)
    v_cmp_ne_u32 vcc, s70, v4
    s_nop 0
    s_cmp_eq_u64 vcc, 0
    s_cbranch_scc1 DH_OUT
    s_mov_b64 exec, vcc
    s_sleep 4
    s_add_u32 s28, s28, 1
    s_cmp_lt_u32 s28, 0x100000
    s_cbranch_scc1 DH_POLL
DH_OUT:
    s_mov_b64 exec, -1
DH_GO:
    buffer_load_dwordx4 v[112:115], v1, s[20:23], s34 offen offset:0 sc1
    buffer_load_dwordx4 v[116:119], v1, s[20:23], s35 offen offset:0 sc1
    buffer_load_dwordx4 v[120:123], v1, s[20:23], s34 offen offset:1024 sc1
    buffer_load_dwordx4 v[124:127], v1, s[20:23], s35 offen offset:1024 sc1
    buffer_load_dwordx4 v[128:131], v1, s[20:23], s34 offen offset:2048 sc1
    buffer_load_dwordx4 v[132:135], v1, s[20:23], s35 offen offset:2048 sc1
    buffer_load_dwordx4 v[136:139], v1, s[20:23], s34 offen offset:3072 sc1
    buffer_load_dwordx4 v[140:143], v1, s[20:23], s35 offen offset:3072 sc1
    ds_read_b64_tr_b16 v[16:17], v5 offset:0
    ds_read_b64_tr_b16 v[18:19], v5 offset:1024
    ds_read_b64_tr_b16 v[20:21], v6 offset:0
    ds_read_b64_tr_b16 v[22:23], v6 offset:1024
    s_mov_b32 s42, 0
    s_mov_b32 s43, 0x7fffffff
    s_add_u32 s44, s32, 8192
    s_add_u32 s45, s45, 32
    s_lshl_b32 s67, s25, 17
    s_add_u32 s67, s67, s55
    s_and_b32 s57, s57, 0xffff
    s_setprio 0
    s_waitcnt vmcnt(0)
    buffer_load_dwordx4 v[144:147], v152, s[16:19], s40 offen offset:0
    buffer_load_dwordx4 v[148:151], v152, s[16:19], s40 offen offset:32
DN_LOOP:
    s_cmp_lg_u32 s42, 12
    s_cbranch_scc1 DB_GO
    s_mov_b32 s28, 0
DB_POLL:
    buffer_load_dword v4, v3, s[20:23], s45 offen sc1
    s_waitcnt vmcnt(0)
    v_cmp_ne_u32 vcc, s70, v4
    s_nop 0
    s_cmp_eq_u64 vcc, 0
    s_cbranch_scc1 DB_OUT
    s_mov_b64 exec, vcc
    s_sleep 4
    s_add_u32 s28, s28, 1
    s_cmp_lt_u32 s28, 0x100000
    s_cbranch_scc1 DB_POLL
DB_OUT:
    s_mov_b64 exec, -1
DB_GO:
    s_add_u32 s34, s34, 4096
    s_add_u32 s35, s35, 4096
    s_cmp_lt_u32 s42, 24
    s_cselect_b32 s34, s34, s43
    s_cselect_b32 s35, s35, s43
    s_waitcnt vmcnt(14) lgkmcnt(0)
    v_mfma_f32_32x32x16_bf16 v[48:63], v[16:19], v[112:115], v[48:63]
    ds_read_b64_tr_b16 v[24:25], v5 offset:2048
    v_mfma_f32_32x32x16_bf16 v[64:79], v[20:23], v[112:115], v[64:79]
    ds_read_b64_tr_b16 v[26:27], v5 offset:3072
    v_mfma_f32_32x32x16_bf16 v[80:95], v[16:19], v[116:119], v[80:95]
    ds_read_b64_tr_b16 v[28:29], v6 offset:2048
    v_mfma_f32_32x32x16_bf16 v[96:111], v[20:23], v[116:119], v[96:111]
    ds_read_b64_tr_b16 v[30:31], v6 offset:3072
    buffer_load_dwordx4 v[112:115], v1, s[20:23], s34 offen offset:0 sc1
    buffer_load_dwordx4 v[116:119], v1, s[20:23], s35 offen offset:0 sc1
    s_add_u32 m0, s44, 6144
    s_nop 0
    buffer_load_dwordx4 v2, s[12:15], s33 offen lds
    buffer_load_dwordx4 v15, s[12:15], s33 offen offset:1024 lds
    s_add_u32 s33, s33, s66
    s_waitcnt vmcnt(14) lgkmcnt(0)
    v_mfma_f32_32x32x16_bf16 v[48:63], v[24:27], v[120:123], v[48:63]
    ds_read_b64_tr_b16 v[16:17], v5 offset:4096
    v_mfma_f32_32x32x16_bf16 v[64:79], v[28:31], v[120:123], v[64:79]
    ds_read_b64_tr_b16 v[18:19], v5 offset:5120
    v_mfma_f32_32x32x16_bf16 v[80:95], v[24:27], v[124:127], v[80:95]
    ds_read_b64_tr_b16 v[20:21], v6 offset:4096
    v_mfma_f32_32x32x16_bf16 v[96:111], v[28:31], v[124:127], v[96:111]
    ds_read_b64_tr_b16 v[22:23], v6 offset:5120
    buffer_load_dwordx4 v[120:123], v1, s[20:23], s34 offen offset:1024 sc1
    buffer_load_dwordx4 v[124:127], v1, s[20:23], s35 offen offset:1024 sc1
    s_cmp_eq_u32 s42, 20
    s_cselect_b32 s12, s56, s12
    s_cselect_b32 s13, s57, s13
    s_cselect_b32 s14, 524288, s14
    s_cselect_b32 s33, s67, s33
    s_cselect_b32 s65, 16384, s65
    s_cselect_b32 s66, 16384, s66
    s_add_u32 m0, s36, 0
    s_nop 0
    buffer_load_dwordx4 v2, s[12:15], s33 offen lds
    buffer_load_dwordx4 v15, s[12:15], s33 offen offset:1024 lds
    s_add_u32 s33, s33, s65
    s_waitcnt vmcnt(14) lgkmcnt(0)
    v_mfma_f32_32x32x16_bf16 v[48:63], v[16:19], v[128:131], v[48:63]
    ds_read_b64_tr_b16 v[24:25], v5 offset:6144
    v_mfma_f32_32x32x16_bf16 v[64:79], v[20:23], v[128:131], v[64:79]
    ds_read_b64_tr_b16 v[26:27], v5 offset:7168
    v_mfma_f32_32x32x16_bf16 v[80:95], v[16:19], v[132:135], v[80:95]
    ds_read_b64_tr_b16 v[28:29], v6 offset:6144
    v_mfma_f32_32x32x16_bf16 v[96:111], v[20:23], v[132:135], v[96:111]
    ds_read_b64_tr_b16 v[30:31], v6 offset:7168
    buffer_load_dwordx4 v[128:131], v1, s[20:23], s34 offen offset:2048 sc1
    buffer_load_dwordx4 v[132:135], v1, s[20:23], s35 offen offset:2048 sc1
    s_add_u32 m0, s36, 2048
    s_nop 0
    buffer_load_dwordx4 v2, s[12:15], s33 offen lds
    buffer_load_dwordx4 v15, s[12:15], s33 offen offset:1024 lds
    s_add_u32 s33, s33, s65
    s_waitcnt vmcnt(14) lgkmcnt(0)
    v_mfma_f32_32x32x16_bf16 v[48:63], v[24:27], v[136:139], v[48:63]
    ds_read_b64_tr_b16 v[16:17], v9 offset:0
    v_mfma_f32_32x32x16_bf16 v[64:79], v[28:31], v[136:139], v[64:79]
    ds_read_b64_tr_b16 v[18:19], v9 offset:1024
    v_mfma_f32_32x32x16_bf16 v[80:95], v[24:27], v[140:143], v[80:95]
    ds_read_b64_tr_b16 v[20:21], v10 offset:0
    v_mfma_f32_32x32x16_bf16 v[96:111], v[28:31], v[140:143], v[96:111]
    ds_read_b64_tr_b16 v[22:23], v10 offset:1024
    buffer_load_dwordx4 v[136:139], v1, s[20:23], s34 offen offset:3072 sc1
    buffer_load_dwordx4 v[140:143], v1, s[20:23], s35 offen offset:3072 sc1
    s_add_u32 m0, s36, 4096
    s_nop 0
    buffer_load_dwordx4 v2, s[12:15], s33 offen lds
    buffer_load_dwordx4 v15, s[12:15], s33 offen offset:1024 lds
    s_add_u32 s33, s33, s65
    s_setprio 3
    v_swap_b32 v5, v9
    v_swap_b32 v6, v10
    s_setprio 0
    s_mov_b32 s28, s36
    s_mov_b32 s36, s44
    s_mov_b32 s44, s28
    s_add_u32 s42, s42, 4
    s_cmp_lt_u32 s42, 28
    s_cbranch_scc1 DN_LOOP
    s_setprio 3
    s_add_u32 m0, s44, 6144
    s_nop 0
    buffer_load_dwordx4 v2, s[12:15], s33 offen lds
    buffer_load_dwordx4 v15, s[12:15], s33 offen offset:1024 lds
    s_add_u32 s33, s33, s65
    s_mov_b32 s16, s58
    s_and_b32 s17, s59, 0xffff
    s_mov_b32 s18, 2097152
    s_mov_b32 s19, 0x20000
    v_lshlrev_b32 v32, 16, v144
    v_and_b32 v33, 0xffff0000, v144
    v_lshlrev_b32 v34, 16, v145
    v_and_b32 v35, 0xffff0000, v145
    v_lshlrev_b32 v36, 16, v146
    v_and_b32 v37, 0xffff0000, v146
    v_lshlrev_b32 v38, 16, v147
    v_and_b32 v39, 0xffff0000, v147
    v_lshlrev_b32 v40, 16, v148
    v_and_b32 v41, 0xffff0000, v148
    v_lshlrev_b32 v42, 16, v149
    v_and_b32 v43, 0xffff0000, v149
    v_lshlrev_b32 v44, 16, v150
    v_and_b32 v45, 0xffff0000, v150
    v_lshlrev_b32 v46, 16, v151
    v_and_b32 v47, 0xffff0000, v151
    v_mov_b32 v160, v152
    s_lshl_b32 s34, s53, 16
    s_lshl_b32 s35, s25, 13
    s_add_u32 s34, s34, s35
    s_add_u32 s34, s34, 16777216
    s_lshl_b32 s28, s63, 15
    s_add_u32 s35, s34, 32768
    s_sub_u32 s35, s35, s28
    s_add_u32 s34, s34, s28
    s_add_u32 s46, s34, 4096
    s_add_u32 s47, s35, 4096
    s_lshl_b32 s45, s53, 3
    s_add_u32 s45, s45, s25
    s_lshl_b32 s45, s45, 5
    s_add_u32 s45, s45, 23101440
    v_lshlrev_b32 v3, 0, v3
    v_add_f32 v48, v48, v32
    v_add_f32 v49, v49, v33
    v_add_f32 v50, v50, v34
    v_add_f32 v51, v51, v35
    v_add_f32 v52, v52, v36
    v_add_f32 v53, v53, v37
    v_add_f32 v54, v54, v38
    v_add_f32 v55, v55, v39
    v_add_f32 v56, v56, v40
    v_add_f32 v57, v57, v41
    v_add_f32 v58, v58, v42
    v_add_f32 v59, v59, v43
    v_add_f32 v60, v60, v44
    v_add_f32 v61, v61, v45
    v_add_f32 v62, v62, v46
    v_add_f32 v63, v63, v47
    v_add_u32 v161, s32, v1
    s_xor_b32 s28, s25, 1
    s_lshl_b32 s28, s28, 14
    s_add_u32 s28, s28, 65536
    v_add_u32 v162, s28, v1
    s_xor_b32 s28, s25, 2
    s_lshl_b32 s28, s28, 14
    s_add_u32 s28, s28, 69632
    v_add_u32 v163, s28, v1
    s_xor_b32 s28, s25, 3
    s_lshl_b32 s28, s28, 14
    s_add_u32 s28, s28, 73728
    v_add_u32 v164, s28, v1
    v_add_u32 v13, 1, v13
    s_mov_b32 s44, 0x11
    s_mov_b32 s28, 0
    s_waitcnt lgkmcnt(0)
    s_barrier
WO_POLL:
    buffer_load_dword v4, v3, s[20:23], s45 offen sc1
    s_waitcnt vmcnt(0)
    v_cmp_eq_u32 vcc, s70, v4
    s_add_u32 s28, s28, 1
    s_cmp_lt_u32 s28, 0x100000
    s_cselect_b32 s42, vcc_lo, -1
    s_lshr_b32 s29, s42, 1
    s_and_b32 s42, s42, s29
    s_lshr_b32 s29, s42, 2
    s_and_b32 s42, s42, s29
    s_and_b32 s42, s42, s44
    s_cbranch_scc1 WO_GO
    s_sleep 3
    s_branch WO_POLL
WO_GO:
    s_andn2_b32 s44, s44, s42
    s_bitcmp1_b32 s42, 0
    s_cbranch_scc0 WO_L0
    buffer_load_dwordx4 v[112:115], v1, s[20:23], s34 offen offset:0 sc1
    buffer_load_dwordx4 v[116:119], v1, s[20:23], s35 offen offset:0 sc1
    buffer_load_dwordx4 v[120:123], v1, s[20:23], s34 offen offset:1024 sc1
    buffer_load_dwordx4 v[124:127], v1, s[20:23], s35 offen offset:1024 sc1
    buffer_load_dwordx4 v[128:131], v1, s[20:23], s34 offen offset:2048 sc1
    buffer_load_dwordx4 v[132:135], v1, s[20:23], s35 offen offset:2048 sc1
    buffer_load_dwordx4 v[136:139], v1, s[20:23], s34 offen offset:3072 sc1
    buffer_load_dwordx4 v[140:143], v1, s[20:23], s35 offen offset:3072 sc1
WO_L0:
    s_bitcmp1_b32 s42, 4
    s_cbranch_scc0 WO_L1
    buffer_load_dwordx4 v[32:35], v1, s[20:23], s46 offen offset:0 sc1
    buffer_load_dwordx4 v[36:39], v1, s[20:23], s47 offen offset:0 sc1
    buffer_load_dwordx4 v[40:43], v1, s[20:23], s46 offen offset:1024 sc1
    buffer_load_dwordx4 v[44:47], v1, s[20:23], s47 offen offset:1024 sc1
    buffer_load_dwordx4 v[144:147], v1, s[20:23], s46 offen offset:2048 sc1
    buffer_load_dwordx4 v[148:151], v1, s[20:23], s47 offen offset:2048 sc1
    buffer_load_dwordx4 v[152:155], v1, s[20:23], s46 offen offset:3072 sc1
    buffer_load_dwordx4 v[156:159], v1, s[20:23], s47 offen offset:3072 sc1
WO_L1:
    s_bitcmp1_b32 s42, 0
    s_cbranch_scc0 WO_C0
    ds_read_b64_tr_b16 v[16:17], v5 offset:0
    ds_read_b64_tr_b16 v[18:19], v5 offset:1024
    ds_read_b64_tr_b16 v[20:21], v6 offset:0
    ds_read_b64_tr_b16 v[22:23], v6 offset:1024
    s_bitcmp1_b32 s42, 4
    s_cbranch_scc1 WO_W8
    s_waitcnt vmcnt(0)
WO_W8:
    s_waitcnt vmcnt(8)
    s_waitcnt lgkmcnt(0)
    v_mfma_f32_32x32x16_bf16 v[48:63], v[16:19], v[112:115], v[48:63]
    ds_read_b64_tr_b16 v[24:25], v5 offset:2048
    v_mfma_f32_32x32x16_bf16 v[64:79], v[20:23], v[112:115], v[64:79]
    ds_read_b64_tr_b16 v[26:27], v5 offset:3072
    v_mfma_f32_32x32x16_bf16 v[80:95], v[16:19], v[116:119], v[80:95]
    ds_read_b64_tr_b16 v[28:29], v6 offset:2048
    v_mfma_f32_32x32x16_bf16 v[96:111], v[20:23], v[116:119], v[96:111]
    ds_read_b64_tr_b16 v[30:31], v6 offset:3072
    s_waitcnt lgkmcnt(0)
    v_mfma_f32_32x32x16_bf16 v[48:63], v[24:27], v[120:123], v[48:63]
    ds_read_b64_tr_b16 v[16:17], v5 offset:4096
    v_mfma_f32_32x32x16_bf16 v[64:79], v[28:31], v[120:123], v[64:79]
    ds_read_b64_tr_b16 v[18:19], v5 offset:5120
    v_mfma_f32_32x32x16_bf16 v[80:95], v[24:27], v[124:127], v[80:95]
    ds_read_b64_tr_b16 v[20:21], v6 offset:4096
    v_mfma_f32_32x32x16_bf16 v[96:111], v[28:31], v[124:127], v[96:111]
    ds_read_b64_tr_b16 v[22:23], v6 offset:5120
    s_waitcnt lgkmcnt(0)
    v_mfma_f32_32x32x16_bf16 v[48:63], v[16:19], v[128:131], v[48:63]
    ds_read_b64_tr_b16 v[24:25], v5 offset:6144
    v_mfma_f32_32x32x16_bf16 v[64:79], v[20:23], v[128:131], v[64:79]
    ds_read_b64_tr_b16 v[26:27], v5 offset:7168
    v_mfma_f32_32x32x16_bf16 v[80:95], v[16:19], v[132:135], v[80:95]
    ds_read_b64_tr_b16 v[28:29], v6 offset:6144
    v_mfma_f32_32x32x16_bf16 v[96:111], v[20:23], v[132:135], v[96:111]
    ds_read_b64_tr_b16 v[30:31], v6 offset:7168
    s_waitcnt lgkmcnt(0)
    v_mfma_f32_32x32x16_bf16 v[48:63], v[24:27], v[136:139], v[48:63]
    v_mfma_f32_32x32x16_bf16 v[64:79], v[28:31], v[136:139], v[64:79]
    v_mfma_f32_32x32x16_bf16 v[80:95], v[24:27], v[140:143], v[80:95]
    v_mfma_f32_32x32x16_bf16 v[96:111], v[28:31], v[140:143], v[96:111]
WO_C0:
    s_bitcmp1_b32 s42, 4
    s_cbranch_scc0 WO_C1
    ds_read_b64_tr_b16 v[16:17], v9 offset:0
    ds_read_b64_tr_b16 v[18:19], v9 offset:1024
    ds_read_b64_tr_b16 v[20:21], v10 offset:0
    ds_read_b64_tr_b16 v[22:23], v10 offset:1024
    s_waitcnt vmcnt(0)
    s_waitcnt lgkmcnt(0)
    v_mfma_f32_32x32x16_bf16 v[48:63], v[16:19], v[32:35], v[48:63]
    ds_read_b64_tr_b16 v[24:25], v9 offset:2048
    v_mfma_f32_32x32x16_bf16 v[64:79], v[20:23], v[32:35], v[64:79]
    ds_read_b64_tr_b16 v[26:27], v9 offset:3072
    v_mfma_f32_32x32x16_bf16 v[80:95], v[16:19], v[36:39], v[80:95]
    ds_read_b64_tr_b16 v[28:29], v10 offset:2048
    v_mfma_f32_32x32x16_bf16 v[96:111], v[20:23], v[36:39], v[96:111]
    ds_read_b64_tr_b16 v[30:31], v10 offset:3072
    s_waitcnt lgkmcnt(0)
    v_mfma_f32_32x32x16_bf16 v[48:63], v[24:27], v[40:43], v[48:63]
    ds_read_b64_tr_b16 v[16:17], v9 offset:4096
    v_mfma_f32_32x32x16_bf16 v[64:79], v[28:31], v[40:43], v[64:79]
    ds_read_b64_tr_b16 v[18:19], v9 offset:5120
    v_mfma_f32_32x32x16_bf16 v[80:95], v[24:27], v[44:47], v[80:95]
    ds_read_b64_tr_b16 v[20:21], v10 offset:4096
    v_mfma_f32_32x32x16_bf16 v[96:111], v[28:31], v[44:47], v[96:111]
    ds_read_b64_tr_b16 v[22:23], v10 offset:5120
    s_waitcnt lgkmcnt(0)
    v_mfma_f32_32x32x16_bf16 v[48:63], v[16:19], v[144:147], v[48:63]
    ds_read_b64_tr_b16 v[24:25], v9 offset:6144
    v_mfma_f32_32x32x16_bf16 v[64:79], v[20:23], v[144:147], v[64:79]
    ds_read_b64_tr_b16 v[26:27], v9 offset:7168
    v_mfma_f32_32x32x16_bf16 v[80:95], v[16:19], v[148:151], v[80:95]
    ds_read_b64_tr_b16 v[28:29], v10 offset:6144
    v_mfma_f32_32x32x16_bf16 v[96:111], v[20:23], v[148:151], v[96:111]
    ds_read_b64_tr_b16 v[30:31], v10 offset:7168
    s_waitcnt lgkmcnt(0)
    v_mfma_f32_32x32x16_bf16 v[48:63], v[24:27], v[152:155], v[48:63]
    v_mfma_f32_32x32x16_bf16 v[64:79], v[28:31], v[152:155], v[64:79]
    v_mfma_f32_32x32x16_bf16 v[80:95], v[24:27], v[156:159], v[80:95]
    v_mfma_f32_32x32x16_bf16 v[96:111], v[28:31], v[156:159], v[96:111]
WO_C1:
    s_cmp_lg_u32 s44, 0
    s_cbranch_scc1 WO_POLL
    s_nop 5
    s_nop 1
    ds_write_b128 v161, v[64:67] offset:0
    ds_write_b128 v161, v[68:71] offset:1024
    ds_write_b128 v161, v[72:75] offset:2048
    ds_write_b128 v161, v[76:79] offset:3072
    ds_write_b128 v161, v[80:83] offset:4096
    ds_write_b128 v161, v[84:87] offset:5120
    ds_write_b128 v161, v[88:91] offset:6144
    ds_write_b128 v161, v[92:95] offset:7168
    ds_write_b128 v161, v[96:99] offset:8192
    ds_write_b128 v161, v[100:103] offset:9216
    ds_write_b128 v161, v[104:107] offset:10240
    ds_write_b128 v161, v[108:111] offset:11264
    s_waitcnt lgkmcnt(0)
    s_barrier
    ds_read_b128 v[64:67], v162 offset:0
    ds_read_b128 v[80:83], v163 offset:0
    ds_read_b128 v[96:99], v164 offset:0
    ds_read_b128 v[68:71], v162 offset:1024
    ds_read_b128 v[84:87], v163 offset:1024
    ds_read_b128 v[100:103], v164 offset:1024
    ds_read_b128 v[72:75], v162 offset:2048
    ds_read_b128 v[88:91], v163 offset:2048
    ds_read_b128 v[104:107], v164 offset:2048
    ds_read_b128 v[76:79], v162 offset:3072
    ds_read_b128 v[92:95], v163 offset:3072
    ds_read_b128 v[108:111], v164 offset:3072
    s_waitcnt lgkmcnt(9)
    v_add_f32 v64, v64, v80
    v_add_f32 v48, v48, v96
    v_add_f32 v65, v65, v81
    v_add_f32 v49, v49, v97
    v_add_f32 v66, v66, v82
    v_add_f32 v50, v50, v98
    v_add_f32 v67, v67, v83
    v_add_f32 v51, v51, v99
    v_add_f32 v48, v48, v64
    v_add_f32 v49, v49, v65
    v_add_f32 v50, v50, v66
    v_add_f32 v51, v51, v67
    v_cvt_pk_bf16_f32 v16, v48, v49
    v_cvt_pk_bf16_f32 v17, v50, v51
    s_waitcnt lgkmcnt(6)
    v_add_f32 v68, v68, v84
    v_add_f32 v52, v52, v100
    v_add_f32 v69, v69, v85
    v_add_f32 v53, v53, v101
    v_add_f32 v70, v70, v86
    v_add_f32 v54, v54, v102
    v_add_f32 v71, v71, v87
    v_add_f32 v55, v55, v103
    v_add_f32 v52, v52, v68
    v_add_f32 v53, v53, v69
    v_add_f32 v54, v54, v70
    v_add_f32 v55, v55, v71
    v_cvt_pk_bf16_f32 v18, v52, v53
    v_cvt_pk_bf16_f32 v19, v54, v55
    buffer_store_dwordx4 v[16:19], v160, s[16:19], s40 offen offset:0
    s_waitcnt lgkmcnt(3)
    v_add_f32 v72, v72, v88
    v_add_f32 v56, v56, v104
    v_add_f32 v73, v73, v89
    v_add_f32 v57, v57, v105
    v_add_f32 v74, v74, v90
    v_add_f32 v58, v58, v106
    v_add_f32 v75, v75, v91
    v_add_f32 v59, v59, v107
    v_add_f32 v56, v56, v72
    v_add_f32 v57, v57, v73
    v_add_f32 v58, v58, v74
    v_add_f32 v59, v59, v75
    v_cvt_pk_bf16_f32 v20, v56, v57
    v_cvt_pk_bf16_f32 v21, v58, v59
    s_waitcnt lgkmcnt(0)
    v_add_f32 v76, v76, v92
    v_add_f32 v60, v60, v108
    v_add_f32 v77, v77, v93
    v_add_f32 v61, v61, v109
    v_add_f32 v78, v78, v94
    v_add_f32 v62, v62, v110
    v_add_f32 v79, v79, v95
    v_add_f32 v63, v63, v111
    v_add_f32 v60, v60, v76
    v_add_f32 v61, v61, v77
    v_add_f32 v62, v62, v78
    v_add_f32 v63, v63, v79
    v_cvt_pk_bf16_f32 v22, v60, v61
    v_cvt_pk_bf16_f32 v23, v62, v63
    buffer_store_dwordx4 v[20:23], v160, s[16:19], s40 offen offset:32
    s_add_u32 s28, s2, s25
    s_cmp_lg_u32 s28, 0
    s_cbranch_scc1 G_NOEP
    v_mov_b32 v2, 0
    v_mov_b32 v3, s70
    s_mov_b32 s28, 23138304
    s_mov_b64 exec, 1
    buffer_store_dword v3, v2, s[20:23], s28 offen sc1
    s_mov_b64 exec, -1
G_NOEP:
    s_endpgm
UB_SPIN:
    s_sleep 1
    ds_read_b32 v14, v12
    s_waitcnt lgkmcnt(0)
    v_cmp_le_u32 vcc, s39, v14
    s_nop 0
    s_cmp_eq_u64 vcc, -1
    s_cbranch_scc0 UB_SPIN
    s_branch UB_CONT
UP_SPIN:
    s_sleep 1
    ds_read_b32 v14, v12
    s_waitcnt lgkmcnt(0)
    v_cmp_le_u32 vcc, s39, v14
    s_nop 0
    s_cmp_eq_u64 vcc, -1
    s_cbranch_scc0 UP_SPIN
    s_branch UP_CONT
U9_SPIN:
    s_sleep 1
    ds_read_b32 v14, v12
    s_waitcnt lgkmcnt(0)
    v_cmp_le_u32 vcc, s39, v14
    s_nop 0
    s_cmp_eq_u64 vcc, -1
    s_cbranch_scc0 U9_SPIN
    s_branch U9_CONT
M_END:
    s_endpgm
.section .rodata,"a"
.p2align 6
.amdhsa_kernel parallel_sum__softmax_full_mha__glu_gated_swiglu__prompt_kernel
  .amdhsa_next_free_vgpr 168
  .amdhsa_next_free_sgpr 72
  .amdhsa_accum_offset 168
  .amdhsa_group_segment_fixed_size 0
  .amdhsa_kernarg_size 80
  .amdhsa_user_sgpr_count 2
  .amdhsa_user_sgpr_kernarg_segment_ptr 1
  .amdhsa_system_sgpr_workgroup_id_x 1
.end_amdhsa_kernel
```
